```python
import torch

def _softmax(x, axis=-1):
    return torch.softmax(x, dim=axis)
def _gelu(x):
    return torch.nn.functional.gelu(x, approximate="tanh")
def _silu(x):
    return torch.nn.functional.silu(x)
def _sigmoid(x):
    return torch.sigmoid(x)
def _layernorm(x, axis=-1, eps=1e-5):
    m = x.mean(dim=axis, keepdim=True)
    v = x.var(dim=axis, keepdim=True, unbiased=False)
    return (x - m) / torch.sqrt(v + eps)
def _scatter_add(tgt, idx, src, axis=0):
    return tgt.clone().index_add_(axis, idx, src)
def _segment_sum(src, seg, n):
    out = torch.zeros((n,) + src.shape[1:], dtype=src.dtype)
    return out.index_add_(0, seg, src)
def _pad(x, pw):
    flat = tuple(v for pair in reversed(pw) for v in pair)
    return torch.nn.functional.pad(x, flat)

kernel_name = 'parallel_sum__sliding_block_cached__glu_gated_geglu__decode'

def setup_inputs():

    _w = (lambda a: (lambda t: t.to(torch.bfloat16) if t.is_floating_point() else t)(torch.as_tensor(a)))
    def _A_setup():
        B, Sq, D = 2, 1, 640
        Hq, Hkv, Sk, Dh = 32, 32, 8192, 192
        assert Hq % Hkv == 0, (Hq, Hkv)
        return {
            "x": _w((lambda *s: torch.randn(*s, dtype=torch.bfloat16) * 0.05)(B, Sq, D)),
            "k_cache": _w((lambda *s: torch.randn(*s, dtype=torch.bfloat16) * 1.6)(B, Hkv, Sk, Dh)),
            "v_cache": _w((lambda *s: torch.randn(*s, dtype=torch.bfloat16) * 0.8)(B, Hkv, Sk, Dh)),
            "wq": _w((lambda *s: torch.randn(*s, dtype=torch.bfloat16) * 1.6)(D, Hq * Dh) * (D ** -0.5)),
            "wo": _w((lambda *s: torch.randn(*s, dtype=torch.bfloat16) * 0.8)(Hq * Dh, D) * ((Hq * Dh) ** -0.5)),
        }
    _A_in = _A_setup()

    def _B_setup():
        B, S, Dm, Df = 2, 1, 640, 1536
        return {
            "x": _w((lambda *s: torch.randn(*s, dtype=torch.bfloat16) * 0.05)(B, S, Dm)),
            "w_gate": _w((lambda *s: torch.randn(*s, dtype=torch.bfloat16) * 0.8)(Dm, Df) * (Dm ** -0.5)),
            "w_up": _w((lambda *s: torch.randn(*s, dtype=torch.bfloat16) * 0.8)(Dm, Df) * (Dm ** -0.5)),
            "w_down": _w((lambda *s: torch.randn(*s, dtype=torch.bfloat16) * 0.8)(Df, Dm) * (Df ** -0.5)),
        }
    _B_in = _B_setup()

    return {
        "A_x": _A_in["x"],
        "A_k_cache": _A_in["k_cache"],
        "A_v_cache": _A_in["v_cache"],
        "A_wq": _A_in["wq"],
        "A_wo": _A_in["wo"],
        "B_x": _B_in["x"],
        "B_w_gate": _B_in["w_gate"],
        "B_w_up": _B_in["w_up"],
        "B_w_down": _B_in["w_down"],
    }

def reference(A_x, A_k_cache, A_v_cache, A_wq, A_wo, B_x, B_w_gate, B_w_up, B_w_down):
    def _A_ref(x, k_cache, v_cache, wq, wo):
        B, Sq, D = x.shape
        Hq, Dh = 32, 192
        Hkv, Sk = k_cache.shape[1], k_cache.shape[2]
        W = min(4096, max(256, Sk // 4))
        rep = Hq // Hkv
        q = (lambda x, *d: x.permute(*d))((x @ wq).reshape(B, Sq, Hq, Dh), 0, 2, 1, 3)
        k = (lambda x, n, axis: torch.repeat_interleave(x, n, dim=axis))(k_cache[:, :, Sk - W:, :], rep, axis=1)
        v = (lambda x, n, axis: torch.repeat_interleave(x, n, dim=axis))(v_cache[:, :, Sk - W:, :], rep, axis=1)
        scores = torch.einsum("bhqd,bhkd->bhqk", q, k) * (Dh ** -0.5)
        p = _softmax(scores, axis=-1)
        o = torch.einsum("bhqk,bhkd->bhqd", p, v)
        return (lambda x, *d: x.permute(*d))(o, 0, 2, 1, 3).reshape(B, Sq, Hq * Dh) @ wo

    def _B_ref(x, w_gate, w_up, w_down):
        g = torch.einsum("bsd,df->bsf", x, w_gate)
        u = torch.einsum("bsd,df->bsf", x, w_up)
        h = _gelu(g) * u
        return torch.einsum("bsf,fd->bsd", h, w_down)

    x = A_x
    xn = _layernorm(x, axis=-1)
    return x + _A_ref(xn, A_k_cache, A_v_cache, A_wq, A_wo) + _B_ref(xn, B_w_gate, B_w_up, B_w_down)
```

```asm
; @launch grid=(256,1,1) block=(768,1,1) lds=106496
.amdgcn_target "amdgcn-amd-amdhsa--gfx950"
.text
.globl parallel_sum__sliding_block_cached__glu_gated_geglu__decode_kernel
.p2align 8
.type parallel_sum__sliding_block_cached__glu_gated_geglu__decode_kernel,@function
parallel_sum__sliding_block_cached__glu_gated_geglu__decode_kernel:
    s_load_dwordx16 s[16:31], s[0:1], 0
    s_load_dwordx8 s[32:39], s[0:1], 64
    s_cmpk_ge_u32 s2, 256
    s_cbranch_scc1 L_end
    s_and_b32 s4, s2, 63
    s_lshr_b32 s5, s2, 6
    s_lshl4_add_u32 s6, s4, 12
    s_lshl3_add_u32 s6, s6, s5
    s_mulk_i32 s6, 24576
    v_and_b32 v6, 7, v0
    v_lshrrev_b32 v1, 3, v0
    v_mul_u32_u24 v1, 384, v1
    v_lshl_add_u32 v2, v6, 4, s6
    v_lshlrev_b32 v3, 2, v0
    v_mov_b32 v40, 0
    v_cmp_lt_u32 vcc, 0x1ff, v0
    v_add_u32 v1, v1, v2
    s_getpc_b64 s[10:11]
L_pc:
    v_subrev_u32 v8, 0x2c0, v0
    v_cmp_gt_u32 s[12:13], 47, v8
    v_lshlrev_b32 v8, 8, v8
    v_mov_b32 v9, 0
    v_lshl_add_u64 v[8:9], v[8:9], 0, s[10:11]
    s_and_saveexec_b64 s[14:15], s[12:13]
    s_cbranch_execz L_npf
    global_load_dword v10, v[8:9], off
    global_load_dword v11, v[8:9], off offset:128
L_npf:
    s_mov_b64 exec, s[14:15]
    ds_write_b32 v3, v40
    s_waitcnt lgkmcnt(0)
    s_cbranch_vccnz L_hb
    global_load_dwordx4 v[48:51], v1, s[18:19] offset:0 nt
    global_load_dwordx4 v[52:55], v1, s[18:19] offset:128 nt
    global_load_dwordx4 v[56:59], v1, s[18:19] offset:256 nt
    v_add_u32 v1, 0x18000, v1
    global_load_dwordx4 v[60:63], v1, s[18:19] offset:0 nt
L_hb:
    s_load_dword s56, s[38:39], 835584
    s_barrier
    s_cbranch_vccnz L_helper
    v_mov_b32 v16, 1
    v_lshrrev_b32 v7, 6, v0
    v_and_b32 v0, 63, v0
    v_mov_b32 v41, 0
    v_readfirstlane_b32 s3, v7
    v_mov_b32 v19, 0xff
    s_waitcnt vmcnt(3)
    global_load_dwordx4 v[64:67], v1, s[18:19] offset:128 nt
    s_mov_b64 exec, 1
    ds_add_rtn_u32 v17, v6, v16 offset:116
    s_mov_b64 exec, -1
    v_lshlrev_b32 v36, 4, v0
    s_mov_b64 s[10:11], 0xffff
    v_cmp_gt_u32 vcc, 4, v6
    v_lshlrev_b64 v[36:37], v36, s[10:11]
    v_mov_b32 v38, 0
    s_waitcnt lgkmcnt(0)
    v_readfirstlane_b32 s26, v17
    s_cmpk_ge_i32 s26, 10
    s_cbranch_scc1 L_ct5
    s_waitcnt vmcnt(3)
    s_cmpk_ge_i32 s26, 6
    s_cbranch_scc1 L_ct5
    s_waitcnt vmcnt(2)
    s_cmpk_ge_i32 s26, -2
    s_cbranch_scc1 L_ct5
    s_waitcnt vmcnt(1)
L_ct5:
    global_load_dwordx4 v[68:71], v1, s[18:19] offset:256 nt
    s_mov_b64 exec, 1
    ds_add_rtn_u32 v17, v6, v16 offset:116
    s_mov_b64 exec, -1
    v_cndmask_b32 v32, 0, v36, vcc
    v_cndmask_b32 v33, 0, v37, vcc
    v_cndmask_b32 v34, v36, v38, vcc
    v_cndmask_b32 v35, v37, v38, vcc
    s_and_b32 s7, s2, 7
    v_add_u32 v1, 0x18000, v1
    s_waitcnt lgkmcnt(0)
    v_readfirstlane_b32 s26, v17
    s_cmpk_ge_i32 s26, 18
    s_cbranch_scc1 L_ct6
    s_waitcnt vmcnt(3)
    s_cmpk_ge_i32 s26, 14
    s_cbranch_scc1 L_ct6
    s_waitcnt vmcnt(2)
    s_cmpk_ge_i32 s26, 6
    s_cbranch_scc1 L_ct6
    s_waitcnt vmcnt(1)
L_ct6:
    s_waitcnt vmcnt(4)
    global_load_dwordx4 v[72:75], v1, s[18:19] offset:0 nt
    s_mov_b64 exec, 1
    ds_add_rtn_u32 v17, v6, v16 offset:116
    s_mov_b64 exec, -1
    s_lshr_b32 s8, s2, 3
    s_max_u32 s10, s8, 2
    s_addk_i32 s10, -2
    s_mul_i32 s9, s10, 26
    s_lshr_b32 s9, s9, 8
    s_waitcnt lgkmcnt(0)
    v_readfirstlane_b32 s26, v17
    s_cmpk_ge_i32 s26, 26
    s_cbranch_scc1 L_ct7
    s_waitcnt vmcnt(3)
    s_cmpk_ge_i32 s26, 22
    s_cbranch_scc1 L_ct7
    s_waitcnt vmcnt(2)
    s_cmpk_ge_i32 s26, 14
    s_cbranch_scc1 L_ct7
    s_waitcnt vmcnt(1)
L_ct7:
    s_waitcnt vmcnt(4)
    global_load_dwordx4 v[76:79], v1, s[18:19] offset:128 nt
    s_mov_b64 exec, 1
    ds_add_rtn_u32 v17, v6, v16 offset:116
    s_mov_b64 exec, -1
    s_mul_i32 s11, s9, 10
    s_sub_u32 s10, s10, s11
    s_lshl3_add_u32 s11, s9, s3
    s_mul_i32 s12, s11, 43
    s_lshr_b32 s12, s12, 8
    s_waitcnt lgkmcnt(0)
    v_readfirstlane_b32 s26, v17
    s_cmpk_ge_i32 s26, 34
    s_cbranch_scc1 L_ct8
    s_waitcnt vmcnt(3)
    s_cmpk_ge_i32 s26, 30
    s_cbranch_scc1 L_ct8
    s_waitcnt vmcnt(2)
    s_cmpk_ge_i32 s26, 22
    s_cbranch_scc1 L_ct8
    s_waitcnt vmcnt(1)
L_ct8:
    s_waitcnt vmcnt(4)
    global_load_dwordx4 v[80:83], v1, s[18:19] offset:256 nt
    s_mov_b64 exec, 1
    ds_add_rtn_u32 v17, v6, v16 offset:116
    s_mov_b64 exec, -1
    s_mulk_i32 s12, 1344
    s_mul_i32 s13, s7, 192
    s_add_u32 s12, s12, s13
    s_lshl_b32 s14, s11, 5
    s_add_u32 s12, s12, s14
    v_add_u32 v1, 0x18000, v1
    s_waitcnt lgkmcnt(0)
    v_readfirstlane_b32 s26, v17
    s_cmpk_ge_i32 s26, 42
    s_cbranch_scc1 L_ct9
    s_waitcnt vmcnt(3)
    s_cmpk_ge_i32 s26, 38
    s_cbranch_scc1 L_ct9
    s_waitcnt vmcnt(2)
    s_cmpk_ge_i32 s26, 30
    s_cbranch_scc1 L_ct9
    s_waitcnt vmcnt(1)
L_ct9:
    s_waitcnt vmcnt(4)
    global_load_dwordx4 v[84:87], v1, s[18:19] offset:0 nt
    s_mov_b64 exec, 1
    ds_add_rtn_u32 v17, v6, v16 offset:116
    s_mov_b64 exec, -1
    s_lshl3_add_u32 s13, s11, s13
    s_mulk_i32 s12, 1280
    s_mulk_i32 s13, 1280
    s_lshl_b32 s14, s10, 7
    s_add_u32 s12, s12, s14
    s_waitcnt lgkmcnt(0)
    v_readfirstlane_b32 s26, v17
    s_cmpk_ge_i32 s26, 50
    s_cbranch_scc1 L_ct10
    s_waitcnt vmcnt(3)
    s_cmpk_ge_i32 s26, 46
    s_cbranch_scc1 L_ct10
    s_waitcnt vmcnt(2)
    s_cmpk_ge_i32 s26, 38
    s_cbranch_scc1 L_ct10
    s_waitcnt vmcnt(1)
L_ct10:
    s_waitcnt vmcnt(4)
    global_load_dwordx4 v[88:91], v1, s[18:19] offset:128 nt
    s_mov_b64 exec, 1
    ds_add_rtn_u32 v17, v6, v16 offset:116
    s_mov_b64 exec, -1
    s_add_u32 s13, s13, s14
    s_add_u32 s40, s24, s12
    s_addc_u32 s41, s25, 0
    s_add_u32 s44, s32, s13
    s_addc_u32 s45, s33, 0
    s_waitcnt lgkmcnt(0)
    v_readfirstlane_b32 s26, v17
    s_cmpk_ge_i32 s26, 58
    s_cbranch_scc1 L_ct11
    s_waitcnt vmcnt(3)
    s_cmpk_ge_i32 s26, 54
    s_cbranch_scc1 L_ct11
    s_waitcnt vmcnt(2)
    s_cmpk_ge_i32 s26, 46
    s_cbranch_scc1 L_ct11
    s_waitcnt vmcnt(1)
L_ct11:
    s_waitcnt vmcnt(4)
    global_load_dwordx4 v[92:95], v1, s[18:19] offset:256 nt
    s_mov_b64 exec, 1
    ds_add_rtn_u32 v17, v6, v16 offset:116
    s_mov_b64 exec, -1
    s_cmp_lt_u32 s8, 2
    s_cselect_b32 s42, 0, 39808
    s_cselect_b32 s46, 0, 9088
    s_mov_b32 s43, 0x20000
    s_mov_b32 s47, 0x20000
    v_add_u32 v1, 0x18000, v1
    s_waitcnt lgkmcnt(0)
    v_readfirstlane_b32 s26, v17
    s_cmpk_ge_i32 s26, 66
    s_cbranch_scc1 L_ct12
    s_waitcnt vmcnt(3)
    s_cmpk_ge_i32 s26, 62
    s_cbranch_scc1 L_ct12
    s_waitcnt vmcnt(2)
    s_cmpk_ge_i32 s26, 54
    s_cbranch_scc1 L_ct12
    s_waitcnt vmcnt(1)
L_ct12:
    s_waitcnt vmcnt(4)
    global_load_dwordx4 v[96:99], v1, s[18:19] offset:0 nt
    s_mov_b64 exec, 1
    ds_add_rtn_u32 v17, v6, v16 offset:116
    s_mov_b64 exec, -1
    s_movk_i32 s48, 10240
    s_movk_i32 s49, 20480
    s_movk_i32 s50, 30720
    s_mul_i32 s51, s3, 6144
    s_add_u32 s51, s51, 57344
    s_waitcnt lgkmcnt(0)
    v_readfirstlane_b32 s26, v17
    s_cmpk_ge_i32 s26, 74
    s_cbranch_scc1 L_ct13
    s_waitcnt vmcnt(3)
    s_cmpk_ge_i32 s26, 70
    s_cbranch_scc1 L_ct13
    s_waitcnt vmcnt(2)
    s_cmpk_ge_i32 s26, 62
    s_cbranch_scc1 L_ct13
    s_waitcnt vmcnt(1)
L_ct13:
    s_waitcnt vmcnt(4)
    global_load_dwordx4 v[100:103], v1, s[18:19] offset:128 nt
    s_mov_b64 exec, 1
    ds_add_rtn_u32 v17, v6, v16 offset:116
    s_mov_b64 exec, -1
    s_mov_b64 exec, 1
    ds_write_b32 v40, v19 offset:108
    s_mov_b64 exec, -1
    s_lshl_b32 s52, s3, 12
    s_addk_i32 s52, 16384
    s_lshl_b32 s53, s3, 10
    s_add_u32 s53, s53, 49152
    s_mov_b32 s60, 0xffff0000
    s_waitcnt lgkmcnt(0)
    v_readfirstlane_b32 s26, v17
    s_cmpk_ge_i32 s26, 82
    s_cbranch_scc1 L_ct14
    s_waitcnt vmcnt(3)
    s_cmpk_ge_i32 s26, 78
    s_cbranch_scc1 L_ct14
    s_waitcnt vmcnt(2)
    s_cmpk_ge_i32 s26, 70
    s_cbranch_scc1 L_ct14
    s_waitcnt vmcnt(1)
L_ct14:
    s_waitcnt vmcnt(4)
    global_load_dwordx4 v[104:107], v1, s[18:19] offset:256 nt
    s_mov_b64 exec, 1
    ds_add_rtn_u32 v17, v6, v16 offset:116
    s_mov_b64 exec, -1
    s_mov_b32 s61, 0x3d93cd3a
    s_mov_b32 s62, 0x3fb8aa3b
    v_lshrrev_b32 v2, 3, v0
    v_and_b32 v3, 6, v2
    v_xor_b32 v3, v3, v6
    v_add_u32 v1, 0x18000, v1
    s_waitcnt lgkmcnt(0)
    v_readfirstlane_b32 s26, v17
    s_cmpk_ge_i32 s26, 90
    s_cbranch_scc1 L_ct15
    s_waitcnt vmcnt(3)
    s_cmpk_ge_i32 s26, 86
    s_cbranch_scc1 L_ct15
    s_waitcnt vmcnt(2)
    s_cmpk_ge_i32 s26, 78
    s_cbranch_scc1 L_ct15
    s_waitcnt vmcnt(1)
L_ct15:
    s_waitcnt vmcnt(4)
    global_load_dwordx4 v[108:111], v1, s[18:19] offset:0 nt
    s_mov_b64 exec, 1
    ds_add_rtn_u32 v17, v6, v16 offset:116
    s_mov_b64 exec, -1
    v_mul_u32_u24 v2, 1280, v2
    v_lshl_add_u32 v2, v3, 4, v2
    v_lshrrev_b32 v38, 5, v0
    v_lshl_add_u32 v39, v7, 1, v38
    v_mul_u32_u24 v39, 768, v39
    s_waitcnt lgkmcnt(0)
    v_readfirstlane_b32 s26, v17
    s_cmpk_ge_i32 s26, 98
    s_cbranch_scc1 L_ct16
    s_waitcnt vmcnt(3)
    s_cmpk_ge_i32 s26, 94
    s_cbranch_scc1 L_ct16
    s_waitcnt vmcnt(2)
    s_cmpk_ge_i32 s26, 86
    s_cbranch_scc1 L_ct16
    s_waitcnt vmcnt(1)
L_ct16:
    s_waitcnt vmcnt(4)
    global_load_dwordx4 v[112:115], v1, s[18:19] offset:128 nt
    s_mov_b64 exec, 1
    ds_add_rtn_u32 v17, v6, v16 offset:116
    s_mov_b64 exec, -1
    v_and_b32 v5, 16, v0
    v_lshl_add_u32 v5, v6, 5, v5
    v_add_u32 v5, v5, v39
    v_bfe_u32 v39, v0, 2, 3
    v_lshlrev_b32 v3, 11, v38
    s_waitcnt lgkmcnt(0)
    v_readfirstlane_b32 s26, v17
    s_cmpk_ge_i32 s26, 106
    s_cbranch_scc1 L_ct17
    s_waitcnt vmcnt(3)
    s_cmpk_ge_i32 s26, 102
    s_cbranch_scc1 L_ct17
    s_waitcnt vmcnt(2)
    s_cmpk_ge_i32 s26, 94
    s_cbranch_scc1 L_ct17
    s_waitcnt vmcnt(1)
L_ct17:
    s_waitcnt vmcnt(4)
    global_load_dwordx4 v[116:119], v1, s[18:19] offset:256 nt
    s_mov_b64 exec, 1
    ds_add_rtn_u32 v17, v6, v16 offset:116
    s_mov_b64 exec, -1
    v_lshl_add_u32 v3, v39, 7, v3
    v_lshrrev_b32 v39, 1, v39
    v_xor_b32 v39, v39, v7
    v_lshl_add_u32 v3, v39, 5, v3
    v_and_b32 v39, 3, v0
    v_add_u32 v1, 0x18000, v1
    s_waitcnt lgkmcnt(0)
    v_readfirstlane_b32 s26, v17
    s_cmpk_ge_i32 s26, 114
    s_cbranch_scc1 L_ct18
    s_waitcnt vmcnt(3)
    s_cmpk_ge_i32 s26, 110
    s_cbranch_scc1 L_ct18
    s_waitcnt vmcnt(2)
    s_cmpk_ge_i32 s26, 102
    s_cbranch_scc1 L_ct18
    s_waitcnt vmcnt(1)
L_ct18:
    s_waitcnt vmcnt(4)
    global_load_dwordx4 v[120:123], v1, s[18:19] offset:0 nt
    s_mov_b64 exec, 1
    ds_add_rtn_u32 v17, v6, v16 offset:116
    s_mov_b64 exec, -1
    v_lshl_add_u32 v3, v39, 3, v3
    v_and_b32 v39, 1, v0
    v_and_b32 v38, 48, v0
    v_mul_u32_u24 v4, 640, v39
    v_add_u32 v4, v4, v38
    s_waitcnt lgkmcnt(0)
    v_readfirstlane_b32 s26, v17
    s_cmpk_ge_i32 s26, 122
    s_cbranch_scc1 L_ct19
    s_waitcnt vmcnt(3)
    s_cmpk_ge_i32 s26, 118
    s_cbranch_scc1 L_ct19
    s_waitcnt vmcnt(2)
    s_cmpk_ge_i32 s26, 110
    s_cbranch_scc1 L_ct19
    s_waitcnt vmcnt(1)
L_ct19:
    s_waitcnt vmcnt(4)
    global_load_dwordx4 v[124:127], v1, s[18:19] offset:128 nt
    s_mov_b64 exec, 1
    ds_add_rtn_u32 v17, v6, v16 offset:116
    s_mov_b64 exec, -1
    s_lshl2_add_u32 s12, s10, s3
    s_and_b32 s13, s3, 1
    s_lshl_b32 s12, s12, 1
    s_sub_u32 s12, s12, s13
    s_lshl_b32 s12, s12, 5
    s_waitcnt lgkmcnt(0)
    v_readfirstlane_b32 s26, v17
    s_cmpk_ge_i32 s26, 130
    s_cbranch_scc1 L_ct20
    s_waitcnt vmcnt(3)
    s_cmpk_ge_i32 s26, 126
    s_cbranch_scc1 L_ct20
    s_waitcnt vmcnt(2)
    s_cmpk_ge_i32 s26, 118
    s_cbranch_scc1 L_ct20
    s_waitcnt vmcnt(1)
L_ct20:
    s_waitcnt vmcnt(4)
    global_load_dwordx4 v[128:131], v1, s[18:19] offset:256 nt
    s_mov_b64 exec, 1
    ds_add_rtn_u32 v17, v6, v16 offset:116
    s_mov_b64 exec, -1
    s_lshl3_add_u32 s13, s9, s7
    s_add_u32 s12, s12, s13
    s_lshl_b32 s12, s12, 7
    s_add_u32 s54, s12, 851968
    v_lshlrev_b32 v6, 4, v6
    v_add_u32 v1, 0x18000, v1
    s_waitcnt lgkmcnt(0)
    v_readfirstlane_b32 s26, v17
    s_cmpk_ge_i32 s26, 138
    s_cbranch_scc1 L_ct21
    s_waitcnt vmcnt(3)
    s_cmpk_ge_i32 s26, 134
    s_cbranch_scc1 L_ct21
    s_waitcnt vmcnt(2)
    s_cmpk_ge_i32 s26, 126
    s_cbranch_scc1 L_ct21
    s_waitcnt vmcnt(1)
L_ct21:
    s_waitcnt vmcnt(4)
    global_load_dwordx4 v[132:135], v1, s[18:19] offset:0 nt
    s_mov_b64 exec, 1
    ds_add_rtn_u32 v17, v6, v16 offset:116
    s_mov_b64 exec, -1
    v_lshlrev_b32 v7, 3, v7
    v_lshl_add_u32 v0, v0, 4, s51
    v_mov_b32 v42, 0
    v_mov_b32 v43, 0
    v_mov_b32 v44, 0
    s_waitcnt lgkmcnt(0)
    v_readfirstlane_b32 s26, v17
    s_cmpk_ge_i32 s26, 146
    s_cbranch_scc1 L_ct22
    s_waitcnt vmcnt(3)
    s_cmpk_ge_i32 s26, 142
    s_cbranch_scc1 L_ct22
    s_waitcnt vmcnt(2)
    s_cmpk_ge_i32 s26, 134
    s_cbranch_scc1 L_ct22
    s_waitcnt vmcnt(1)
L_ct22:
    s_waitcnt vmcnt(4)
    global_load_dwordx4 v[136:139], v1, s[18:19] offset:128 nt
    s_mov_b64 exec, 1
    ds_add_rtn_u32 v17, v6, v16 offset:116
    s_mov_b64 exec, -1
    v_mov_b32 v45, 0
    v_mov_b32 v46, 0
    v_mov_b32 v47, 0
    s_waitcnt lgkmcnt(0)
    v_readfirstlane_b32 s26, v17
    s_cmpk_ge_i32 s26, 154
    s_cbranch_scc1 L_ct23
    s_waitcnt vmcnt(3)
    s_cmpk_ge_i32 s26, 150
    s_cbranch_scc1 L_ct23
    s_waitcnt vmcnt(2)
    s_cmpk_ge_i32 s26, 142
    s_cbranch_scc1 L_ct23
    s_waitcnt vmcnt(1)
L_ct23:
    s_waitcnt vmcnt(4)
    global_load_dwordx4 v[140:143], v1, s[18:19] offset:256 nt
    s_mov_b64 exec, 1
    ds_add_rtn_u32 v17, v6, v16 offset:116
    s_mov_b64 exec, -1
    s_add_u32 m0, s51, 0
    v_add_u32 v1, 0xfff58000, v1
    s_waitcnt lgkmcnt(0)
    v_readfirstlane_b32 s26, v17
    s_cmpk_ge_i32 s26, 162
    s_cbranch_scc1 L_ct24
    s_waitcnt vmcnt(3)
    s_cmpk_ge_i32 s26, 158
    s_cbranch_scc1 L_ct24
    s_waitcnt vmcnt(2)
    s_cmpk_ge_i32 s26, 150
    s_cbranch_scc1 L_ct24
    s_waitcnt vmcnt(1)
L_ct24:
    s_waitcnt vmcnt(4)
    global_load_lds_dwordx4 v1, s[20:21] offset:0 nt
    s_mov_b64 exec, 1
    ds_add_rtn_u32 v17, v6, v16 offset:116
    s_mov_b64 exec, -1
    s_add_u32 m0, s51, 896
    s_waitcnt lgkmcnt(0)
    v_readfirstlane_b32 s26, v17
    s_cmpk_ge_i32 s26, 170
    s_cbranch_scc1 L_ct25
    s_waitcnt vmcnt(3)
    s_cmpk_ge_i32 s26, 166
    s_cbranch_scc1 L_ct25
    s_waitcnt vmcnt(2)
    s_cmpk_ge_i32 s26, 158
    s_cbranch_scc1 L_ct25
    s_waitcnt vmcnt(1)
L_ct25:
    s_waitcnt vmcnt(4)
    global_load_lds_dwordx4 v1, s[20:21] offset:128 nt
    s_mov_b64 exec, 1
    ds_add_rtn_u32 v17, v6, v16 offset:116
    s_mov_b64 exec, -1
    s_add_u32 m0, s51, 1792
    s_waitcnt lgkmcnt(0)
    v_readfirstlane_b32 s26, v17
    s_cmpk_ge_i32 s26, 178
    s_cbranch_scc1 L_ct26
    s_waitcnt vmcnt(3)
    s_cmpk_ge_i32 s26, 174
    s_cbranch_scc1 L_ct26
    s_waitcnt vmcnt(2)
    s_cmpk_ge_i32 s26, 166
    s_cbranch_scc1 L_ct26
    s_waitcnt vmcnt(1)
L_ct26:
    s_waitcnt vmcnt(4)
    global_load_lds_dwordx4 v1, s[20:21] offset:256 nt
    s_mov_b64 exec, 1
    ds_add_rtn_u32 v17, v6, v16 offset:116
    s_mov_b64 exec, -1
    s_add_u32 m0, s51, 3072
    v_add_u32 v1, 0x18000, v1
    s_waitcnt lgkmcnt(0)
    v_readfirstlane_b32 s26, v17
    s_cmpk_ge_i32 s26, 186
    s_cbranch_scc1 L_ct27
    s_waitcnt vmcnt(3)
    s_cmpk_ge_i32 s26, 182
    s_cbranch_scc1 L_ct27
    s_waitcnt vmcnt(2)
    s_cmpk_ge_i32 s26, 174
    s_cbranch_scc1 L_ct27
    s_waitcnt vmcnt(1)
L_ct27:
    s_waitcnt vmcnt(4)
    global_load_lds_dwordx4 v1, s[20:21] offset:0 nt
    s_mov_b64 exec, 1
    ds_add_rtn_u32 v17, v6, v16 offset:116
    s_mov_b64 exec, -1
    s_add_u32 m0, s51, 3968
    s_waitcnt lgkmcnt(0)
    v_readfirstlane_b32 s26, v17
    s_cmpk_ge_i32 s26, 194
    s_cbranch_scc1 L_ct28
    s_waitcnt vmcnt(3)
    s_cmpk_ge_i32 s26, 190
    s_cbranch_scc1 L_ct28
    s_waitcnt vmcnt(2)
    s_cmpk_ge_i32 s26, 182
    s_cbranch_scc1 L_ct28
    s_waitcnt vmcnt(1)
L_ct28:
    s_waitcnt vmcnt(4)
    global_load_lds_dwordx4 v1, s[20:21] offset:128 nt
    s_mov_b64 exec, 1
    ds_add_rtn_u32 v17, v6, v16 offset:116
    s_mov_b64 exec, -1
L_qw:
    ds_read_b32 v22, v40 offset:104
    ds_read_b128 v[8:11], v6 offset:128
    ds_read_b128 v[12:15], v6 offset:256
    ds_read_b128 v[24:27], v6 offset:384
    s_waitcnt lgkmcnt(0)
    v_cmp_eq_u32 vcc, 0, v22
    s_cbranch_vccnz L_qw
    v_dot2c_f32_bf16 v40, v48, v8
    v_dot2c_f32_bf16 v41, v60, v8
    v_dot2c_f32_bf16 v40, v49, v9
    v_dot2c_f32_bf16 v41, v61, v9
    v_dot2c_f32_bf16 v40, v50, v10
    v_dot2c_f32_bf16 v41, v62, v10
    v_dot2c_f32_bf16 v40, v51, v11
    v_dot2c_f32_bf16 v41, v63, v11
    v_dot2c_f32_bf16 v40, v52, v12
    v_dot2c_f32_bf16 v41, v64, v12
    v_dot2c_f32_bf16 v40, v53, v13
    v_dot2c_f32_bf16 v41, v65, v13
    v_dot2c_f32_bf16 v40, v54, v14
    v_dot2c_f32_bf16 v41, v66, v14
    v_dot2c_f32_bf16 v40, v55, v15
    v_dot2c_f32_bf16 v41, v67, v15
    v_dot2c_f32_bf16 v40, v56, v24
    v_dot2c_f32_bf16 v41, v68, v24
    v_dot2c_f32_bf16 v40, v57, v25
    v_dot2c_f32_bf16 v41, v69, v25
    v_dot2c_f32_bf16 v40, v58, v26
    v_dot2c_f32_bf16 v41, v70, v26
    v_dot2c_f32_bf16 v40, v59, v27
    v_dot2c_f32_bf16 v41, v71, v27
    v_dot2c_f32_bf16 v42, v72, v8
    v_dot2c_f32_bf16 v43, v84, v8
    v_dot2c_f32_bf16 v42, v73, v9
    v_dot2c_f32_bf16 v43, v85, v9
    v_dot2c_f32_bf16 v42, v74, v10
    v_dot2c_f32_bf16 v43, v86, v10
    v_dot2c_f32_bf16 v42, v75, v11
    v_dot2c_f32_bf16 v43, v87, v11
    v_dot2c_f32_bf16 v42, v76, v12
    v_dot2c_f32_bf16 v43, v88, v12
    v_dot2c_f32_bf16 v42, v77, v13
    v_dot2c_f32_bf16 v43, v89, v13
    v_dot2c_f32_bf16 v42, v78, v14
    v_dot2c_f32_bf16 v43, v90, v14
    v_dot2c_f32_bf16 v42, v79, v15
    v_dot2c_f32_bf16 v43, v91, v15
    s_add_u32 m0, s51, 4864
    s_waitcnt lgkmcnt(0)
    v_readfirstlane_b32 s26, v17
    s_cmpk_ge_i32 s26, 202
    s_cbranch_scc1 L_ct29
    s_waitcnt vmcnt(3)
    s_cmpk_ge_i32 s26, 198
    s_cbranch_scc1 L_ct29
    s_waitcnt vmcnt(2)
    s_cmpk_ge_i32 s26, 190
    s_cbranch_scc1 L_ct29
    s_waitcnt vmcnt(1)
L_ct29:
    s_waitcnt vmcnt(4)
    global_load_lds_dwordx4 v1, s[20:21] offset:256 nt
    s_mov_b64 exec, 1
    ds_add_rtn_u32 v17, v6, v16 offset:116
    s_mov_b64 exec, -1
    v_dot2c_f32_bf16 v42, v80, v24
    v_dot2c_f32_bf16 v43, v92, v24
    v_dot2c_f32_bf16 v42, v81, v25
    v_dot2c_f32_bf16 v43, v93, v25
    v_dot2c_f32_bf16 v42, v82, v26
    v_dot2c_f32_bf16 v43, v94, v26
    v_dot2c_f32_bf16 v42, v83, v27
    v_dot2c_f32_bf16 v43, v95, v27
    v_dot2c_f32_bf16 v44, v96, v8
    v_dot2c_f32_bf16 v45, v108, v8
    v_dot2c_f32_bf16 v44, v97, v9
    v_dot2c_f32_bf16 v45, v109, v9
    v_dot2c_f32_bf16 v44, v98, v10
    v_dot2c_f32_bf16 v45, v110, v10
    v_dot2c_f32_bf16 v44, v99, v11
    v_dot2c_f32_bf16 v45, v111, v11
    v_dot2c_f32_bf16 v44, v100, v12
    v_dot2c_f32_bf16 v45, v112, v12
    v_dot2c_f32_bf16 v44, v101, v13
    v_dot2c_f32_bf16 v45, v113, v13
    v_dot2c_f32_bf16 v44, v102, v14
    v_dot2c_f32_bf16 v45, v114, v14
    v_dot2c_f32_bf16 v44, v103, v15
    v_dot2c_f32_bf16 v45, v115, v15
    v_dot2c_f32_bf16 v44, v104, v24
    v_dot2c_f32_bf16 v45, v116, v24
    v_dot2c_f32_bf16 v44, v105, v25
    v_dot2c_f32_bf16 v45, v117, v25
    v_dot2c_f32_bf16 v44, v106, v26
    v_dot2c_f32_bf16 v45, v118, v26
    v_dot2c_f32_bf16 v44, v107, v27
    v_dot2c_f32_bf16 v45, v119, v27
    v_dot2c_f32_bf16 v46, v120, v8
    v_dot2c_f32_bf16 v47, v132, v8
    v_dot2c_f32_bf16 v46, v121, v9
    v_dot2c_f32_bf16 v47, v133, v9
    v_dot2c_f32_bf16 v46, v122, v10
    v_dot2c_f32_bf16 v47, v134, v10
    v_dot2c_f32_bf16 v46, v123, v11
    v_dot2c_f32_bf16 v47, v135, v11
    v_add_u32 v1, 0x18000, v1
    s_waitcnt lgkmcnt(0)
    v_readfirstlane_b32 s26, v17
    s_cmpk_ge_i32 s26, 210
    s_cbranch_scc1 L_ct30
    s_waitcnt vmcnt(3)
    s_cmpk_ge_i32 s26, 206
    s_cbranch_scc1 L_ct30
    s_waitcnt vmcnt(2)
    s_cmpk_ge_i32 s26, 198
    s_cbranch_scc1 L_ct30
    s_waitcnt vmcnt(1)
L_ct30:
    s_waitcnt vmcnt(4)
    global_load_dwordx4 v[144:147], v1, s[20:21] offset:0 nt
    s_mov_b64 exec, 1
    ds_add_rtn_u32 v17, v6, v16 offset:116
    s_mov_b64 exec, -1
    v_dot2c_f32_bf16 v46, v124, v12
    v_dot2c_f32_bf16 v47, v136, v12
    v_dot2c_f32_bf16 v46, v125, v13
    v_dot2c_f32_bf16 v47, v137, v13
    v_dot2c_f32_bf16 v46, v126, v14
    v_dot2c_f32_bf16 v47, v138, v14
    v_dot2c_f32_bf16 v46, v127, v15
    v_dot2c_f32_bf16 v47, v139, v15
    v_dot2c_f32_bf16 v46, v128, v24
    v_dot2c_f32_bf16 v47, v140, v24
    v_dot2c_f32_bf16 v46, v129, v25
    v_dot2c_f32_bf16 v47, v141, v25
    v_dot2c_f32_bf16 v46, v130, v26
    v_dot2c_f32_bf16 v47, v142, v26
    v_dot2c_f32_bf16 v46, v131, v27
    v_dot2c_f32_bf16 v47, v143, v27
    s_waitcnt lgkmcnt(0)
    v_readfirstlane_b32 s26, v17
    s_cmpk_ge_i32 s26, 218
    s_cbranch_scc1 L_ct31
    s_waitcnt vmcnt(3)
    s_cmpk_ge_i32 s26, 214
    s_cbranch_scc1 L_ct31
    s_waitcnt vmcnt(2)
    s_cmpk_ge_i32 s26, 206
    s_cbranch_scc1 L_ct31
    s_waitcnt vmcnt(1)
L_ct31:
    s_waitcnt vmcnt(4)
    global_load_dwordx4 v[148:151], v1, s[20:21] offset:128 nt
    s_mov_b64 exec, 1
    ds_add_rtn_u32 v17, v6, v16 offset:116
    s_mov_b64 exec, -1
    s_waitcnt lgkmcnt(0)
    v_readfirstlane_b32 s26, v17
    s_cmpk_ge_i32 s26, 226
    s_cbranch_scc1 L_ct32
    s_waitcnt vmcnt(3)
    s_cmpk_ge_i32 s26, 222
    s_cbranch_scc1 L_ct32
    s_waitcnt vmcnt(2)
    s_cmpk_ge_i32 s26, 214
    s_cbranch_scc1 L_ct32
    s_waitcnt vmcnt(1)
L_ct32:
    s_waitcnt vmcnt(4)
    global_load_dwordx4 v[152:155], v1, s[20:21] offset:256 nt
    s_mov_b64 exec, 1
    ds_add_rtn_u32 v17, v6, v16 offset:116
    s_mov_b64 exec, -1
    v_add_u32 v1, 0x18000, v1
    s_waitcnt lgkmcnt(0)
    v_readfirstlane_b32 s26, v17
    s_cmpk_ge_i32 s26, 234
    s_cbranch_scc1 L_ct33
    s_waitcnt vmcnt(3)
    s_cmpk_ge_i32 s26, 230
    s_cbranch_scc1 L_ct33
    s_waitcnt vmcnt(2)
    s_cmpk_ge_i32 s26, 222
    s_cbranch_scc1 L_ct33
    s_waitcnt vmcnt(1)
L_ct33:
    s_waitcnt vmcnt(4)
    global_load_dwordx4 v[156:159], v1, s[20:21] offset:0 nt
    s_mov_b64 exec, 1
    ds_add_rtn_u32 v17, v6, v16 offset:116
    s_mov_b64 exec, -1
    s_waitcnt lgkmcnt(0)
    v_readfirstlane_b32 s26, v17
    s_cmpk_ge_i32 s26, 242
    s_cbranch_scc1 L_ct34
    s_waitcnt vmcnt(3)
    s_cmpk_ge_i32 s26, 238
    s_cbranch_scc1 L_ct34
    s_waitcnt vmcnt(2)
    s_cmpk_ge_i32 s26, 230
    s_cbranch_scc1 L_ct34
    s_waitcnt vmcnt(1)
L_ct34:
    s_waitcnt vmcnt(4)
    global_load_dwordx4 v[160:163], v1, s[20:21] offset:128 nt
    s_mov_b64 exec, 1
    ds_add_rtn_u32 v17, v6, v16 offset:116
    s_mov_b64 exec, -1
    ds_read_b128 v[96:99], v0 offset:0
    ds_read_b128 v[100:103], v0 offset:1024
    ds_read_b128 v[104:107], v0 offset:2048
    ds_read_b128 v[108:111], v0 offset:3072
    ds_read_b128 v[112:115], v0 offset:4096
    ds_read_b128 v[116:119], v0 offset:5120
    v_add_f32_dpp v40, v40, v40 quad_perm:[1,0,3,2] row_mask:0xf bank_mask:0xf
    v_add_f32_dpp v41, v41, v41 quad_perm:[1,0,3,2] row_mask:0xf bank_mask:0xf
    v_add_f32_dpp v42, v42, v42 quad_perm:[1,0,3,2] row_mask:0xf bank_mask:0xf
    v_add_f32_dpp v43, v43, v43 quad_perm:[1,0,3,2] row_mask:0xf bank_mask:0xf
    v_add_f32_dpp v44, v44, v44 quad_perm:[1,0,3,2] row_mask:0xf bank_mask:0xf
    v_add_f32_dpp v45, v45, v45 quad_perm:[1,0,3,2] row_mask:0xf bank_mask:0xf
    v_add_f32_dpp v46, v46, v46 quad_perm:[1,0,3,2] row_mask:0xf bank_mask:0xf
    v_add_f32_dpp v47, v47, v47 quad_perm:[1,0,3,2] row_mask:0xf bank_mask:0xf
    v_add_f32_dpp v40, v40, v40 quad_perm:[2,3,0,1] row_mask:0xf bank_mask:0xf
    v_add_f32_dpp v41, v41, v41 quad_perm:[2,3,0,1] row_mask:0xf bank_mask:0xf
    v_add_f32_dpp v42, v42, v42 quad_perm:[2,3,0,1] row_mask:0xf bank_mask:0xf
    v_add_f32_dpp v43, v43, v43 quad_perm:[2,3,0,1] row_mask:0xf bank_mask:0xf
    v_add_f32_dpp v44, v44, v44 quad_perm:[2,3,0,1] row_mask:0xf bank_mask:0xf
    v_add_f32_dpp v45, v45, v45 quad_perm:[2,3,0,1] row_mask:0xf bank_mask:0xf
    v_add_f32_dpp v46, v46, v46 quad_perm:[2,3,0,1] row_mask:0xf bank_mask:0xf
    v_add_f32_dpp v47, v47, v47 quad_perm:[2,3,0,1] row_mask:0xf bank_mask:0xf
    v_add_f32_dpp v40, v40, v40 row_half_mirror row_mask:0xf bank_mask:0xf
    v_add_f32_dpp v41, v41, v41 row_half_mirror row_mask:0xf bank_mask:0xf
    v_add_f32_dpp v42, v42, v42 row_half_mirror row_mask:0xf bank_mask:0xf
    v_add_f32_dpp v43, v43, v43 row_half_mirror row_mask:0xf bank_mask:0xf
    v_add_f32_dpp v44, v44, v44 row_half_mirror row_mask:0xf bank_mask:0xf
    v_add_f32_dpp v45, v45, v45 row_half_mirror row_mask:0xf bank_mask:0xf
    v_add_f32_dpp v46, v46, v46 row_half_mirror row_mask:0xf bank_mask:0xf
    v_add_f32_dpp v47, v47, v47 row_half_mirror row_mask:0xf bank_mask:0xf
    v_cvt_pk_bf16_f32 v41, v40, v41
    v_cvt_pk_bf16_f32 v43, v42, v43
    v_cvt_pk_bf16_f32 v45, v44, v45
    v_cvt_pk_bf16_f32 v47, v46, v47
    v_lshlrev_b32 v40, 16, v41
    v_and_b32 v41, s60, v41
    v_lshlrev_b32 v42, 16, v43
    v_and_b32 v43, s60, v43
    v_lshlrev_b32 v44, 16, v45
    v_and_b32 v45, s60, v45
    s_waitcnt lgkmcnt(0)
    v_readfirstlane_b32 s26, v17
    s_cmpk_ge_i32 s26, 250
    s_cbranch_scc1 L_ct35
    s_waitcnt vmcnt(3)
    s_cmpk_ge_i32 s26, 246
    s_cbranch_scc1 L_ct35
    s_waitcnt vmcnt(2)
    s_cmpk_ge_i32 s26, 238
    s_cbranch_scc1 L_ct35
    s_waitcnt vmcnt(1)
L_ct35:
    s_waitcnt vmcnt(4)
    global_load_dwordx4 v[164:167], v1, s[20:21] offset:256 nt
    s_mov_b64 exec, 1
    ds_add_rtn_u32 v17, v6, v16 offset:116
    s_mov_b64 exec, -1
    v_lshlrev_b32 v46, 16, v47
    v_and_b32 v47, s60, v47
    v_mul_f32 v40, s61, v40
    v_mul_f32 v41, s61, v41
    v_mul_f32 v42, s61, v42
    v_mul_f32 v43, s61, v43
    v_mul_f32 v44, s61, v44
    v_mul_f32 v45, s61, v45
    v_mul_f32 v46, s61, v46
    v_mul_f32 v47, s61, v47
    v_cvt_pk_bf16_f32 v41, v40, v41
    v_cvt_pk_bf16_f32 v43, v42, v43
    v_cvt_pk_bf16_f32 v45, v44, v45
    v_cvt_pk_bf16_f32 v47, v46, v47
    v_lshlrev_b32 v40, 16, v41
    v_and_b32 v41, s60, v41
    v_lshlrev_b32 v42, 16, v43
    v_and_b32 v43, s60, v43
    v_lshlrev_b32 v44, 16, v45
    v_and_b32 v45, s60, v45
    v_lshlrev_b32 v46, 16, v47
    v_and_b32 v47, s60, v47
    v_max3_f32 v8, v40, v41, v42
    v_max3_f32 v37, v43, v44, v45
    v_max3_f32 v8, v8, v46, v47
    v_max_f32 v8, v8, v37
    s_nop 1
    v_max_f32_dpp v8, v8, v8 row_ror:8 row_mask:0xf bank_mask:0xf
    v_mov_b32 v37, v8
    s_nop 1
    v_permlane16_swap_b32 v8, v37
    v_max_f32 v8, v8, v37
    v_mov_b32 v37, v8
    s_nop 1
    v_permlane32_swap_b32 v8, v37
    v_max_f32 v8, v8, v37
    v_mul_f32 v8, s62, v8
    v_fma_f32 v40, v40, s62, -v8
    v_fma_f32 v41, v41, s62, -v8
    v_fma_f32 v42, v42, s62, -v8
    v_add_u32 v1, 0x18000, v1
    s_waitcnt lgkmcnt(0)
    v_readfirstlane_b32 s26, v17
    s_cmpk_ge_i32 s26, 258
    s_cbranch_scc1 L_ct36
    s_waitcnt vmcnt(3)
    s_cmpk_ge_i32 s26, 254
    s_cbranch_scc1 L_ct36
    s_waitcnt vmcnt(2)
    s_cmpk_ge_i32 s26, 246
    s_cbranch_scc1 L_ct36
    s_waitcnt vmcnt(1)
L_ct36:
    s_waitcnt vmcnt(4)
    global_load_dwordx4 v[48:51], v1, s[20:21] offset:0 nt
    s_mov_b64 exec, 1
    ds_add_rtn_u32 v17, v6, v16 offset:116
    s_mov_b64 exec, -1
    v_fma_f32 v43, v43, s62, -v8
    v_fma_f32 v44, v44, s62, -v8
    v_fma_f32 v45, v45, s62, -v8
    v_fma_f32 v46, v46, s62, -v8
    v_fma_f32 v47, v47, s62, -v8
    v_exp_f32 v40, v40
    v_exp_f32 v41, v41
    v_exp_f32 v42, v42
    v_exp_f32 v43, v43
    v_exp_f32 v44, v44
    v_exp_f32 v45, v45
    v_exp_f32 v46, v46
    v_exp_f32 v47, v47
    v_add_f32 v36, v40, v41
    v_add_f32 v37, v42, v43
    v_add_f32 v38, v44, v45
    v_add_f32 v39, v46, v47
    v_add_f32 v36, v36, v37
    v_add_f32 v38, v38, v39
    v_add_f32 v9, v36, v38
    v_cvt_pk_bf16_f32 v40, v40, v40
    v_cvt_pk_bf16_f32 v41, v41, v41
    v_cvt_pk_bf16_f32 v42, v42, v42
    v_cvt_pk_bf16_f32 v43, v43, v43
    v_cvt_pk_bf16_f32 v44, v44, v44
    v_cvt_pk_bf16_f32 v45, v45, v45
    v_cvt_pk_bf16_f32 v46, v46, v46
    v_cvt_pk_bf16_f32 v47, v47, v47
    s_nop 1
    v_add_f32_dpp v9, v9, v9 row_ror:8 row_mask:0xf bank_mask:0xf
    v_mov_b32 v37, v9
    s_nop 1
    v_permlane16_swap_b32 v9, v37
    v_add_f32 v9, v9, v37
    v_mov_b32 v37, v9
    s_nop 1
    v_permlane32_swap_b32 v9, v37
    v_add_f32 v9, v9, v37
    s_mov_b64 exec, 1
    ds_write_b64 v7, v[8:9] offset:0
    s_mov_b64 exec, -1
    s_add_u32 s56, s56, 0x9b5f3701
    s_lshr_b32 s57, s56, 8
    s_waitcnt lgkmcnt(0)
    v_readfirstlane_b32 s26, v17
    s_cmpk_ge_i32 s26, 266
    s_cbranch_scc1 L_ct37
    s_waitcnt vmcnt(3)
    s_cmpk_ge_i32 s26, 262
    s_cbranch_scc1 L_ct37
    s_waitcnt vmcnt(2)
    s_cmpk_ge_i32 s26, 254
    s_cbranch_scc1 L_ct37
    s_waitcnt vmcnt(1)
L_ct37:
    s_waitcnt vmcnt(4)
    global_load_dwordx4 v[52:55], v1, s[20:21] offset:128 nt
    s_mov_b64 exec, 1
    ds_add_rtn_u32 v17, v6, v16 offset:116
    s_mov_b64 exec, -1
    s_lshr_b32 s58, s56, 16
    s_lshr_b32 s59, s56, 24
    v_lshrrev_b32 v10, 2, v6
    v_lshrrev_b32 v11, 1, v7
    v_and_b32 v18, 0x80, v4
    v_lshrrev_b32 v18, 1, v18
    v_and_or_b32 v18, v4, 48, v18
    v_add_u32 v18, s54, v18
    v_and_b32 v12, 32, v6
    v_lshl_add_u32 v18, v12, 8, v18
    s_waitcnt lgkmcnt(0)
    v_and_b32 v36, v32, v40
    v_and_b32 v37, v33, v40
    v_and_b32 v38, v34, v40
    v_and_b32 v39, v35, v40
    s_nop 1
    v_mfma_f32_16x16x32_bf16 v[20:23], v[36:39], v[96:99], 0
    v_mfma_f32_16x16x32_bf16 v[24:27], v[36:39], v[100:103], 0
    v_mfma_f32_16x16x32_bf16 v[28:31], v[36:39], v[104:107], 0
    v_and_b32 v36, v32, v41
    v_and_b32 v37, v33, v41
    v_and_b32 v38, v34, v41
    v_and_b32 v39, v35, v41
    s_nop 1
    v_mfma_f32_16x16x32_bf16 v[20:23], v[36:39], v[108:111], v[20:23]
    v_mfma_f32_16x16x32_bf16 v[24:27], v[36:39], v[112:115], v[24:27]
    v_mfma_f32_16x16x32_bf16 v[28:31], v[36:39], v[116:119], v[28:31]
    v_and_b32 v36, v32, v42
    v_and_b32 v37, v33, v42
    v_and_b32 v38, v34, v42
    v_and_b32 v39, v35, v42
    s_nop 1
    v_mfma_f32_16x16x32_bf16 v[20:23], v[36:39], v[144:147], v[20:23]
    v_mfma_f32_16x16x32_bf16 v[24:27], v[36:39], v[148:151], v[24:27]
    v_mfma_f32_16x16x32_bf16 v[28:31], v[36:39], v[152:155], v[28:31]
    v_and_b32 v36, v32, v43
    v_and_b32 v37, v33, v43
    v_and_b32 v38, v34, v43
    v_and_b32 v39, v35, v43
    s_waitcnt lgkmcnt(0)
    v_readfirstlane_b32 s26, v17
    s_cmpk_ge_i32 s26, 274
    s_cbranch_scc1 L_ct38
    s_waitcnt vmcnt(3)
    s_cmpk_ge_i32 s26, 270
    s_cbranch_scc1 L_ct38
    s_waitcnt vmcnt(2)
    s_cmpk_ge_i32 s26, 262
    s_cbranch_scc1 L_ct38
    s_waitcnt vmcnt(1)
L_ct38:
    s_waitcnt vmcnt(4)
    global_load_dwordx4 v[56:59], v1, s[20:21] offset:256 nt
    s_mov_b64 exec, 1
    ds_add_rtn_u32 v17, v6, v16 offset:116
    s_mov_b64 exec, -1
    v_mfma_f32_16x16x32_bf16 v[20:23], v[36:39], v[156:159], v[20:23]
    v_add_u32 v1, 0x18000, v1
    s_waitcnt lgkmcnt(0)
    v_readfirstlane_b32 s26, v17
    s_cmpk_ge_i32 s26, 282
    s_cbranch_scc1 L_ct39
    s_waitcnt vmcnt(3)
    s_cmpk_ge_i32 s26, 278
    s_cbranch_scc1 L_ct39
    s_waitcnt vmcnt(2)
    s_cmpk_ge_i32 s26, 270
    s_cbranch_scc1 L_ct39
    s_waitcnt vmcnt(1)
L_ct39:
    s_waitcnt vmcnt(4)
    global_load_dwordx4 v[60:63], v1, s[20:21] offset:0 nt
    s_mov_b64 exec, 1
    ds_add_rtn_u32 v17, v6, v16 offset:116
    s_mov_b64 exec, -1
    v_mfma_f32_16x16x32_bf16 v[24:27], v[36:39], v[160:163], v[24:27]
    s_waitcnt lgkmcnt(0)
    v_readfirstlane_b32 s26, v17
    s_cmpk_ge_i32 s26, 290
    s_cbranch_scc1 L_ct40
    s_waitcnt vmcnt(4)
    s_cmpk_ge_i32 s26, 286
    s_cbranch_scc1 L_ct40
    s_waitcnt vmcnt(3)
    s_cmpk_ge_i32 s26, 278
    s_cbranch_scc1 L_ct40
    s_waitcnt vmcnt(2)
L_ct40:
    global_load_dwordx4 v[64:67], v1, s[20:21] offset:128 nt
    s_mov_b64 exec, 1
    ds_add_rtn_u32 v17, v6, v16 offset:116
    s_mov_b64 exec, -1
    s_waitcnt lgkmcnt(0)
    v_readfirstlane_b32 s26, v17
    s_cmpk_ge_i32 s26, 298
    s_cbranch_scc1 L_ct41
    s_waitcnt vmcnt(5)
    s_cmpk_ge_i32 s26, 294
    s_cbranch_scc1 L_ct41
    s_waitcnt vmcnt(4)
    s_cmpk_ge_i32 s26, 286
    s_cbranch_scc1 L_ct41
    s_waitcnt vmcnt(3)
L_ct41:
    global_load_dwordx4 v[68:71], v1, s[20:21] offset:256 nt
    s_mov_b64 exec, 1
    ds_add_rtn_u32 v17, v6, v16 offset:116
    s_mov_b64 exec, -1
    v_add_u32 v1, 0x18000, v1
    s_waitcnt lgkmcnt(0)
    v_readfirstlane_b32 s26, v17
    s_cmpk_ge_i32 s26, 306
    s_cbranch_scc1 L_ct42
    s_waitcnt vmcnt(5)
    s_cmpk_ge_i32 s26, 302
    s_cbranch_scc1 L_ct42
    s_waitcnt vmcnt(4)
    s_cmpk_ge_i32 s26, 294
    s_cbranch_scc1 L_ct42
    s_waitcnt vmcnt(3)
L_ct42:
    s_waitcnt vmcnt(6)
    global_load_dwordx4 v[72:75], v1, s[20:21] offset:0 nt
    s_mov_b64 exec, 1
    ds_add_rtn_u32 v17, v6, v16 offset:116
    s_mov_b64 exec, -1
    v_mfma_f32_16x16x32_bf16 v[28:31], v[36:39], v[164:167], v[28:31]
    v_and_b32 v36, v32, v44
    v_and_b32 v37, v33, v44
    v_and_b32 v38, v34, v44
    v_and_b32 v39, v35, v44
    s_waitcnt lgkmcnt(0)
    v_readfirstlane_b32 s26, v17
    s_cmpk_ge_i32 s26, 314
    s_cbranch_scc1 L_ct43
    s_waitcnt vmcnt(5)
    s_cmpk_ge_i32 s26, 310
    s_cbranch_scc1 L_ct43
    s_waitcnt vmcnt(4)
    s_cmpk_ge_i32 s26, 302
    s_cbranch_scc1 L_ct43
    s_waitcnt vmcnt(3)
L_ct43:
    s_waitcnt vmcnt(6)
    global_load_dwordx4 v[76:79], v1, s[20:21] offset:128 nt
    s_mov_b64 exec, 1
    ds_add_rtn_u32 v17, v6, v16 offset:116
    s_mov_b64 exec, -1
    v_mfma_f32_16x16x32_bf16 v[20:23], v[36:39], v[48:51], v[20:23]
    s_waitcnt lgkmcnt(0)
    v_readfirstlane_b32 s26, v17
    s_cmpk_ge_i32 s26, 322
    s_cbranch_scc1 L_ct44
    s_waitcnt vmcnt(5)
    s_cmpk_ge_i32 s26, 318
    s_cbranch_scc1 L_ct44
    s_waitcnt vmcnt(4)
    s_cmpk_ge_i32 s26, 310
    s_cbranch_scc1 L_ct44
    s_waitcnt vmcnt(3)
L_ct44:
    s_waitcnt vmcnt(6)
    global_load_dwordx4 v[80:83], v1, s[20:21] offset:256 nt
    s_mov_b64 exec, 1
    ds_add_rtn_u32 v17, v6, v16 offset:116
    s_mov_b64 exec, -1
    v_mfma_f32_16x16x32_bf16 v[24:27], v[36:39], v[52:55], v[24:27]
    v_add_u32 v1, 0x18000, v1
    s_waitcnt lgkmcnt(0)
    v_readfirstlane_b32 s26, v17
    s_cmpk_ge_i32 s26, 330
    s_cbranch_scc1 L_ct45
    s_waitcnt vmcnt(5)
    s_cmpk_ge_i32 s26, 326
    s_cbranch_scc1 L_ct45
    s_waitcnt vmcnt(4)
    s_cmpk_ge_i32 s26, 318
    s_cbranch_scc1 L_ct45
    s_waitcnt vmcnt(3)
L_ct45:
    s_waitcnt vmcnt(6)
    global_load_dwordx4 v[84:87], v1, s[20:21] offset:0 nt
    s_mov_b64 exec, 1
    ds_add_rtn_u32 v17, v6, v16 offset:116
    s_mov_b64 exec, -1
    v_mfma_f32_16x16x32_bf16 v[28:31], v[36:39], v[56:59], v[28:31]
    v_and_b32 v36, v32, v45
    v_and_b32 v37, v33, v45
    v_and_b32 v38, v34, v45
    v_and_b32 v39, v35, v45
    s_waitcnt lgkmcnt(0)
    v_readfirstlane_b32 s26, v17
    s_cmpk_ge_i32 s26, 338
    s_cbranch_scc1 L_ct46
    s_waitcnt vmcnt(5)
    s_cmpk_ge_i32 s26, 334
    s_cbranch_scc1 L_ct46
    s_waitcnt vmcnt(4)
    s_cmpk_ge_i32 s26, 326
    s_cbranch_scc1 L_ct46
    s_waitcnt vmcnt(3)
L_ct46:
    s_waitcnt vmcnt(6)
    global_load_dwordx4 v[88:91], v1, s[20:21] offset:128 nt
    s_mov_b64 exec, 1
    ds_add_rtn_u32 v17, v6, v16 offset:116
    s_mov_b64 exec, -1
    v_mfma_f32_16x16x32_bf16 v[20:23], v[36:39], v[60:63], v[20:23]
    s_waitcnt lgkmcnt(0)
    v_readfirstlane_b32 s26, v17
    s_cmpk_ge_i32 s26, 346
    s_cbranch_scc1 L_ct47
    s_waitcnt vmcnt(5)
    s_cmpk_ge_i32 s26, 342
    s_cbranch_scc1 L_ct47
    s_waitcnt vmcnt(4)
    s_cmpk_ge_i32 s26, 334
    s_cbranch_scc1 L_ct47
    s_waitcnt vmcnt(3)
L_ct47:
    s_waitcnt vmcnt(6)
    global_load_dwordx4 v[92:95], v1, s[20:21] offset:256 nt
    s_mov_b64 exec, 1
    ds_add_rtn_u32 v17, v6, v16 offset:116
    s_mov_b64 exec, -1
    v_mfma_f32_16x16x32_bf16 v[24:27], v[36:39], v[64:67], v[24:27]
    s_add_u32 m0, s52, 0
    s_waitcnt lgkmcnt(0)
    v_readfirstlane_b32 s26, v17
    s_cmpk_ge_i32 s26, 354
    s_cbranch_scc1 L_ct48
    s_waitcnt vmcnt(3)
    s_cmpk_ge_i32 s26, 350
    s_cbranch_scc1 L_ct48
    s_waitcnt vmcnt(2)
    s_cmpk_ge_i32 s26, 342
    s_cbranch_scc1 L_ct48
    s_waitcnt vmcnt(1)
L_ct48:
    s_waitcnt vmcnt(4)
    buffer_load_dwordx4 v2, s[40:43], 0 offen nt lds
    s_mov_b64 exec, 1
    ds_add_rtn_u32 v17, v6, v16 offset:116
    s_mov_b64 exec, -1
    v_mfma_f32_16x16x32_bf16 v[28:31], v[36:39], v[68:71], v[28:31]
    v_and_b32 v36, v32, v46
    v_and_b32 v37, v33, v46
    v_and_b32 v38, v34, v46
    v_and_b32 v39, v35, v46
    s_nop 1
    v_mfma_f32_16x16x32_bf16 v[20:23], v[36:39], v[72:75], v[20:23]
    v_mfma_f32_16x16x32_bf16 v[24:27], v[36:39], v[76:79], v[24:27]
    s_add_u32 m0, s52, 1024
    s_waitcnt lgkmcnt(0)
    v_readfirstlane_b32 s26, v17
    s_cmpk_ge_i32 s26, 362
    s_cbranch_scc1 L_ct49
    s_waitcnt vmcnt(3)
    s_cmpk_ge_i32 s26, 358
    s_cbranch_scc1 L_ct49
    s_waitcnt vmcnt(2)
    s_cmpk_ge_i32 s26, 350
    s_cbranch_scc1 L_ct49
    s_waitcnt vmcnt(1)
L_ct49:
    s_waitcnt vmcnt(4)
    buffer_load_dwordx4 v2, s[40:43], s48 offen nt lds
    s_mov_b64 exec, 1
    ds_add_rtn_u32 v17, v6, v16 offset:116
    s_mov_b64 exec, -1
    v_mfma_f32_16x16x32_bf16 v[28:31], v[36:39], v[80:83], v[28:31]
    v_and_b32 v36, v32, v47
    v_and_b32 v37, v33, v47
    v_and_b32 v38, v34, v47
    v_and_b32 v39, v35, v47
    s_add_u32 m0, s52, 2048
    s_waitcnt lgkmcnt(0)
    v_readfirstlane_b32 s26, v17
    s_cmpk_ge_i32 s26, 370
    s_cbranch_scc1 L_ct50
    s_waitcnt vmcnt(3)
    s_cmpk_ge_i32 s26, 366
    s_cbranch_scc1 L_ct50
    s_waitcnt vmcnt(2)
L_ct50:
    s_waitcnt vmcnt(4)
    buffer_load_dwordx4 v2, s[40:43], s49 offen nt lds
    s_mov_b64 exec, 1
    ds_add_rtn_u32 v17, v6, v16 offset:116
    s_mov_b64 exec, -1
    v_mfma_f32_16x16x32_bf16 v[20:23], v[36:39], v[84:87], v[20:23]
    s_waitcnt vmcnt(4)
    v_mfma_f32_16x16x32_bf16 v[24:27], v[36:39], v[88:91], v[24:27]
    s_waitcnt vmcnt(3)
    v_mfma_f32_16x16x32_bf16 v[28:31], v[36:39], v[92:95], v[28:31]
    s_mov_b32 exec_lo, 0xff00ff
    s_mov_b32 exec_hi, 0xff00ff00
    s_cmp_lt_u32 s8, 2
    s_nop 2
    ds_write_b128 v5, v[20:23] offset:3072
    ds_write_b128 v5, v[24:27] offset:3328
    ds_write_b128 v5, v[28:31] offset:3584
    s_mov_b64 exec, 1
    s_waitcnt lgkmcnt(0)
    s_barrier
    s_cbranch_scc1 L_send
    s_mov_b64 exec, -1
    s_add_u32 m0, s52, 3072
    s_barrier
    buffer_load_dwordx4 v2, s[40:43], s50 offen nt lds
    s_mov_b32 m0, s53
    s_nop 0
    buffer_load_dwordx4 v2, s[44:47], 0 offen nt lds
    s_mov_b64 exec, 1
    s_cmp_ge_u32 s3, 4
    s_waitcnt vmcnt(2)
    ds_add_u32 v6, v16 offset:120
    s_waitcnt vmcnt(1)
    ds_add_u32 v6, v16 offset:120
    s_waitcnt vmcnt(0)
    ds_write_b32 v11, v19 offset:64
    s_cbranch_scc1 L_send
    s_mov_b64 exec, -1
    ds_read_b128 v[120:123], v4 offset:1024
    ds_read_b128 v[124:127], v4 offset:1088
L_wf:
    ds_read_b32 v36, v10 offset:64
    s_waitcnt lgkmcnt(0)
    v_cmp_eq_u32 vcc, 0, v36
    s_cbranch_vccnz L_wf
    ds_read_b64_tr_b16 v[80:81], v3 offset:49152
    ds_read_b64_tr_b16 v[82:83], v3 offset:50176
    ds_read_b64_tr_b16 v[84:85], v3 offset:53248
    ds_read_b64_tr_b16 v[86:87], v3 offset:54272
    ds_read_b64_tr_b16 v[48:49], v3 offset:16384
    ds_read_b64_tr_b16 v[50:51], v3 offset:17408
    ds_read_b64_tr_b16 v[52:53], v3 offset:20480
    ds_read_b64_tr_b16 v[54:55], v3 offset:21504
    ds_read_b64_tr_b16 v[56:57], v3 offset:24576
    ds_read_b64_tr_b16 v[58:59], v3 offset:25600
    ds_read_b64_tr_b16 v[60:61], v3 offset:28672
    ds_read_b64_tr_b16 v[62:63], v3 offset:29696
    s_waitcnt lgkmcnt(6)
    v_mfma_f32_16x16x32_bf16 v[20:23], v[80:83], v[120:123], 0
    v_mfma_f32_16x16x32_bf16 v[20:23], v[84:87], v[124:127], v[20:23]
    ds_read_b64_tr_b16 v[64:65], v3 offset:32768
    ds_read_b64_tr_b16 v[66:67], v3 offset:33792
    ds_read_b64_tr_b16 v[68:69], v3 offset:36864
    ds_read_b64_tr_b16 v[70:71], v3 offset:37888
    ds_read_b64_tr_b16 v[72:73], v3 offset:40960
    ds_read_b64_tr_b16 v[74:75], v3 offset:41984
    ds_read_b64_tr_b16 v[76:77], v3 offset:45056
    ds_read_b64_tr_b16 v[78:79], v3 offset:46080
    s_barrier
    ds_read_b128 v[88:91], v4 offset:512
    ds_read_b128 v[92:95], v4 offset:576
    ds_read_b128 v[96:99], v4 offset:640
    ds_read_b128 v[100:103], v4 offset:704
    ds_read_b128 v[104:107], v4 offset:768
    ds_read_b128 v[108:111], v4 offset:832
    ds_read_b128 v[112:115], v4 offset:896
    ds_read_b128 v[116:119], v4 offset:960
    s_waitcnt lgkmcnt(7)
    v_mfma_f32_16x16x32_bf16 v[20:23], v[48:51], v[88:91], v[20:23]
    s_waitcnt lgkmcnt(6)
    v_mfma_f32_16x16x32_bf16 v[20:23], v[52:55], v[92:95], v[20:23]
    s_waitcnt lgkmcnt(5)
    v_mfma_f32_16x16x32_bf16 v[20:23], v[56:59], v[96:99], v[20:23]
    s_waitcnt lgkmcnt(4)
    v_mfma_f32_16x16x32_bf16 v[20:23], v[60:63], v[100:103], v[20:23]
    s_waitcnt lgkmcnt(3)
    v_mfma_f32_16x16x32_bf16 v[20:23], v[64:67], v[104:107], v[20:23]
    s_waitcnt lgkmcnt(2)
    v_mfma_f32_16x16x32_bf16 v[20:23], v[68:71], v[108:111], v[20:23]
    s_waitcnt lgkmcnt(1)
    v_mfma_f32_16x16x32_bf16 v[20:23], v[72:75], v[112:115], v[20:23]
    s_waitcnt lgkmcnt(0)
    v_mfma_f32_16x16x32_bf16 v[20:23], v[76:79], v[116:119], v[20:23]
    s_mov_b32 exec_lo, 0xf000f
    s_mov_b32 exec_hi, 0xf000f
    s_nop 5
    v_bfi_b32 v20, v19, s56, v20
    v_bfi_b32 v21, v19, s57, v21
    v_bfi_b32 v22, v19, s58, v22
    v_bfi_b32 v23, v19, s59, v23
    global_store_dwordx4 v18, v[20:23], s[38:39] sc1
    s_barrier
L_send:
L_end:
    s_waitcnt lgkmcnt(0)
    s_endpgm
L_helper:
    v_lshrrev_b32 v1, 6, v0
    v_and_b32 v0, 63, v0
    s_setprio 3
    v_readfirstlane_b32 s3, v1
    s_and_b32 s7, s2, 7
    s_lshr_b32 s8, s2, 3
    s_max_u32 s10, s8, 2
    s_addk_i32 s10, -2
    s_mul_i32 s9, s10, 26
    s_lshr_b32 s9, s9, 8
    s_mul_i32 s11, s9, 10
    s_sub_u32 s10, s10, s11
    s_mov_b32 s52, 32768
    v_lshlrev_b32 v46, 4, v0
    s_cmp_lg_u32 s3, 11
    s_cbranch_scc1 L_gemv
    s_getreg_b32 s14, hwreg(HW_REG_XCC_ID, 0, 4)
    s_lshl3_add_u32 s12, s14, s7
    s_lshl_b32 s12, s12, 7
    s_add_u32 s12, s12, 819200
    v_lshl_add_u32 v14, v0, 2, s12
    v_mov_b32 v47, v46
    s_lshl_b64 exec, 1, s8
    s_movk_i32 s52, 24
    s_waitcnt lgkmcnt(0)
    s_add_u32 s56, s56, 0x9b5f3701
    s_lshr_b32 s57, s56, 8
    s_lshr_b32 s58, s56, 16
    s_lshr_b32 s59, s56, 24
    v_mov_b32 v12, s56
    global_store_dword v14, v12, s[38:39]
    s_mov_b32 exec_lo, -1
    s_mov_b32 s13, 1
L_fl:
    global_load_dword v16, v14, s[38:39] nt
    s_sub_u32 s52, s52, 1
    s_waitcnt vmcnt(0)
    v_cmp_ne_u32 vcc, s56, v16
    s_cbranch_scc1 L_fldone
    s_cbranch_vccnz L_fl
    s_mov_b32 s13, 2
L_fldone:
    v_mov_b32 v13, s13
    ds_write_b32 v40, v13 offset:96
    s_mov_b32 s63, s13
    v_mov_b32 v15, 835584
    s_mov_b64 exec, -1
    s_cmp_ge_u32 s8, 5
    s_cbranch_scc1 L_bal
    s_mul_i32 s12, s7, 5
    s_add_u32 s12, s12, s8
    s_and_b32 s13, s12, 1
    s_sub_u32 s13, s12, s13
    s_add_u32 s13, s13, s12
    s_lshl_b32 s13, s13, 12
    s_add_u32 s13, s13, 851968
    s_lshl_b32 s12, s12, 5
    v_bfe_u32 v8, v0, 2, 1
    v_and_b32 v9, 3, v0
    v_mul_u32_u24 v8, 1280, v8
    v_lshl_add_u32 v8, v9, 3, v8
    v_lshrrev_b32 v9, 4, v0
    v_lshl_add_u32 v9, v9, 1, s12
    v_add_u32 v12, v8, v9
    global_load_ushort v14, v12, s[16:17]
    v_add_u32 v47, s13, v46
    v_mov_b32 v15, 835584
    v_mov_b32 v13, s56
    v_not_b32 v60, s56
    v_not_b32 v64, s56
    v_not_b32 v68, s56
    s_movk_i32 s62, 0xff00
L_bal:
    s_lshl_b32 s12, s7, 8
    s_add_u32 s13, s12, 843776
    v_lshl_add_u32 v21, v0, 2, s13
    s_lshl2_add_u32 s13, s8, s13
    v_mov_b32 v22, s13
    v_mov_b32 v20, 0
    s_mov_b32 s15, 0
    ds_read_b32 v27, v40 offset:116
    s_movk_i32 s52, 64
    s_cmp_lg_u32 s63, 2
    s_cbranch_scc1 L_pdone
L_pl:
    ds_read_b32 v23, v40 offset:116
    s_waitcnt lgkmcnt(0)
    v_add_u32 v23, v23, v20
    v_add_u32 v24, s56, v23
    v_readfirstlane_b32 s12, v23
    s_mov_b64 exec, 1
    global_store_dword v22, v24, s[38:39]
    s_mov_b64 exec, -1
    s_cmpk_ge_u32 s12, 320
    s_cbranch_scc1 L_pdone
    global_load_dword v25, v21, s[38:39] nt
    v_add_u32 v26, v23, v27
    v_mov_b32 v27, v23
    s_waitcnt vmcnt(0)
    v_subrev_u32 v25, s56, v25
    v_cmp_gt_u32 vcc, 0x200, v25
    v_readlane_b32 s15, v25, 33
    v_lshlrev_b32 v25, 1, v25
    v_cndmask_b32 v25, v26, v25, vcc
    v_lshlrev_b32 v26, 5, v26
    s_sub_u32 s52, s52, 1
    v_add_u32_dpp v25, v25, v25 quad_perm:[1,0,3,2] row_mask:0xf bank_mask:0xf
    s_nop 1
    v_add_u32_dpp v25, v25, v25 quad_perm:[2,3,0,1] row_mask:0xf bank_mask:0xf
    s_nop 1
    v_add_u32_dpp v25, v25, v25 row_half_mirror row_mask:0xf bank_mask:0xf
    s_nop 1
    v_add_u32_dpp v25, v25, v25 row_mirror row_mask:0xf bank_mask:0xf
    v_mov_b32 v24, v25
    s_nop 1
    v_permlane16_swap_b32 v25, v24
    v_add_u32 v25, v25, v24
    v_sub_u32 v26, v26, v25
    v_ashrrev_i32 v26, 7, v26
    v_add_u32 v26, 2, v26
    v_sub_u32 v24, v20, v26
    v_mov_b32 v20, v26
    s_mov_b64 exec, 1
    ds_add_u32 v40, v24 offset:116
    s_mov_b64 exec, -1
    s_cbranch_scc0 L_pl
L_pdone:
    s_cmp_ge_u32 s8, 5
    s_cbranch_scc1 L_cend
    s_mov_b32 s52, 32768
    s_waitcnt vmcnt(0) lgkmcnt(0)
    s_cmp_eq_u32 s15, 1
    s_cselect_b32 s12, 0x2000, 0
    v_add_u32 v47, s12, v47
    v_lshlrev_b32 v14, 16, v14
    s_barrier
    s_barrier
L_fin:
    s_barrier
    s_barrier
L_gb:
    global_load_dwordx4 v[60:63], v47, s[38:39] offset:0 sc1
    global_load_dwordx4 v[64:67], v47, s[38:39] offset:1024 sc1
    global_load_dwordx4 v[68:71], v47, s[38:39] offset:2048 sc1
    s_sub_u32 s52, s52, 1
    s_waitcnt vmcnt(6)
    v_xor_b32 v8, s56, v60
    v_bitop3_b32 v8, v8, v61, s57 bitop3:0xf6
    v_bitop3_b32 v8, v8, v62, s58 bitop3:0xf6
    v_bitop3_b32 v8, v8, v63, s59 bitop3:0xf6
    v_bitop3_b32 v8, v8, v64, s56 bitop3:0xf6
    v_bitop3_b32 v8, v8, v65, s57 bitop3:0xf6
    v_bitop3_b32 v8, v8, v66, s58 bitop3:0xf6
    v_bitop3_b32 v8, v8, v67, s59 bitop3:0xf6
    v_bitop3_b32 v8, v8, v68, s56 bitop3:0xf6
    v_bitop3_b32 v8, v8, v69, s57 bitop3:0xf6
    v_bitop3_b32 v8, v8, v70, s58 bitop3:0xf6
    v_bitop3_b32 v8, v8, v71, s59 bitop3:0xf6
    v_cmp_ne_u32_sdwa vcc, v8, 0 src0_sel:BYTE_0 src1_sel:DWORD
    s_cbranch_scc1 L_gbdone
    s_mov_b64 exec, vcc
    s_cbranch_execnz L_gb
L_gbdone:
    s_mov_b64 exec, -1
    v_and_b32 v48, s62, v60
    v_and_b32 v49, s62, v61
    v_and_b32 v50, s62, v62
    v_and_b32 v51, s62, v63
    v_and_b32 v52, s62, v64
    v_and_b32 v53, s62, v65
    v_and_b32 v54, s62, v66
    v_and_b32 v55, s62, v67
    v_and_b32 v56, s62, v68
    v_and_b32 v57, s62, v69
    v_and_b32 v58, s62, v70
    v_and_b32 v59, s62, v71
    v_pk_add_f32 v[48:49], v[48:49], v[52:53]
    v_pk_add_f32 v[50:51], v[50:51], v[54:55]
    v_pk_add_f32 v[48:49], v[48:49], v[56:57]
    v_pk_add_f32 v[50:51], v[50:51], v[58:59]
    s_nop 1
    v_permlane32_swap_b32 v48, v50
    v_permlane32_swap_b32 v49, v51
    v_pk_add_f32 v[48:49], v[48:49], v[50:51]
    s_nop 1
    v_permlane16_swap_b32 v48, v49
    v_add_f32 v48, v48, v49
    s_nop 1
    v_add_f32_dpp v48, v48, v48 row_ror:8 row_mask:0xf bank_mask:0xf
    s_mov_b32 exec_lo, 0xff00ff
    s_mov_b32 exec_hi, 0xff00ff
    v_add_f32 v48, v48, v14
    v_cvt_pk_bf16_f32 v48, v48, v48
    global_store_short v12, v48, s[34:35]
    s_cmp_eq_u32 s2, 0
    s_cselect_b64 exec, 1, 0
    global_store_dword v15, v13, s[38:39]
    s_waitcnt vmcnt(0)
L_cend:
L_lose:
    s_endpgm
L_gemv:
    v_lshrrev_b32 v4, 4, v0
    v_and_b32 v3, 15, v0
    v_bfe_u32 v5, v0, 3, 1
    s_lshr_b32 s13, s2, 5
    s_and_b32 s14, s2, 31
    s_mul_i32 s12, s13, 160
    v_lshl_add_u32 v7, v4, 3, v6
    v_mul_u32_u24 v28, 1280, v5
    v_mad_u32_u24 v29, v7, 40, v28
    v_min_u32 v30, 19, v7
    v_lshl_add_u32 v30, v30, 3, v28
    v_add_u32 v30, s12, v30
    global_load_dwordx4 v[8:11], v29, s[16:17]
    global_load_dwordx4 v[12:15], v29, s[16:17] offset:16
    global_load_dwordx2 v[16:17], v29, s[16:17] offset:32
    global_load_dwordx2 v[18:19], v30, s[16:17]
    s_bfe_u32 s6, s2, 0x10004
    s_and_b32 s11, s3, 1
    s_movk_i32 s48, 3072
    s_bitcmp1_b32 s2, 3
    s_cselect_b64 s[44:45], s[30:31], s[28:29]
    s_cmp_lt_u32 s3, 10
    s_cselect_b64 s[44:45], s[22:23], s[44:45]
    s_cmovk_i32 s48, 12288
    s_cselect_b32 s15, s14, s7
    s_cselect_b32 s6, s11, s6
    s_mulk_i32 s15, 384
    s_lshl_b32 s11, s6, 8
    s_add_u32 s15, s15, s11
    s_mul_i32 s46, s48, 80
    s_mul_i32 s11, s46, s13
    s_add_u32 s15, s15, s11
    s_add_u32 s44, s44, s15
    s_addc_u32 s45, s45, 0
    s_mov_b32 s47, 0x20000
    s_lshr_b32 s15, 16, s6
    s_mul_i32 s11, s48, 20
    v_cmp_gt_u32 vcc, s15, v3
    v_mul_u32_u24 v1, s11, v4
    v_lshl_add_u32 v1, v3, 4, v1
    v_mov_b32 v31, 0x80000000
    v_cndmask_b32 v1, v31, v1, vcc
    s_mov_b32 s49, 0
    buffer_load_dwordx4 v[48:51], v1, s[44:47], s49 offen nt
    s_add_u32 s49, s49, s48
    buffer_load_dwordx4 v[52:55], v1, s[44:47], s49 offen nt
    s_add_u32 s49, s49, s48
    buffer_load_dwordx4 v[56:59], v1, s[44:47], s49 offen nt
    s_add_u32 s49, s49, s48
    buffer_load_dwordx4 v[60:63], v1, s[44:47], s49 offen nt
    s_add_u32 s49, s49, s48
    buffer_load_dwordx4 v[64:67], v1, s[44:47], s49 offen nt
    s_add_u32 s49, s49, s48
    buffer_load_dwordx4 v[68:71], v1, s[44:47], s49 offen nt
    s_add_u32 s49, s49, s48
    buffer_load_dwordx4 v[72:75], v1, s[44:47], s49 offen nt
    s_add_u32 s49, s49, s48
    buffer_load_dwordx4 v[76:79], v1, s[44:47], s49 offen nt
    s_add_u32 s49, s49, s48
    buffer_load_dwordx4 v[80:83], v1, s[44:47], s49 offen nt
    s_add_u32 s49, s49, s48
    buffer_load_dwordx4 v[84:87], v1, s[44:47], s49 offen nt
    s_add_u32 s49, s49, s48
    buffer_load_dwordx4 v[88:91], v1, s[44:47], s49 offen nt
    s_add_u32 s49, s49, s48
    buffer_load_dwordx4 v[92:95], v1, s[44:47], s49 offen nt
    s_add_u32 s49, s49, s48
    buffer_load_dwordx4 v[96:99], v1, s[44:47], s49 offen nt
    s_add_u32 s49, s49, s48
    buffer_load_dwordx4 v[100:103], v1, s[44:47], s49 offen nt
    s_add_u32 s49, s49, s48
    buffer_load_dwordx4 v[104:107], v1, s[44:47], s49 offen nt
    s_add_u32 s49, s49, s48
    buffer_load_dwordx4 v[108:111], v1, s[44:47], s49 offen nt
    s_add_u32 s49, s49, s48
    buffer_load_dwordx4 v[112:115], v1, s[44:47], s49 offen nt
    s_add_u32 s49, s49, s48
    buffer_load_dwordx4 v[116:119], v1, s[44:47], s49 offen nt
    s_add_u32 s49, s49, s48
    buffer_load_dwordx4 v[120:123], v1, s[44:47], s49 offen nt
    s_add_u32 s49, s49, s48
    buffer_load_dwordx4 v[124:127], v1, s[44:47], s49 offen nt
    s_mov_b64 s[40:41], s[38:39]
    s_mov_b32 s42, 974848
    s_mov_b32 s43, 0x20000
    s_lshl4_add_u32 s50, s14, s13
    s_mulk_i32 s50, 768
    s_bfe_u32 s11, s2, 0x10003
    s_lshl1_add_u32 s11, s7, s11
    s_mulk_i32 s11, 12288
    s_lshl_b32 s15, s13, 9
    s_add_u32 s11, s11, s15
    s_add_u32 s11, s11, 393216
    s_and_b32 s15, s13, 1
    s_lshl1_add_u32 s53, s14, s15
    s_mulk_i32 s53, 6144
    s_mul_i32 s15, s7, 6
    s_add_u32 s15, s15, s9
    s_lshl_b32 s15, s15, 12
    s_add_u32 s15, s15, 393216
    s_movk_i32 s54, 256
    s_movk_i32 s55, 4096
    s_movk_i32 s51, 512
    s_movk_i32 s49, 11776
    s_movk_i32 s48, 1008
    s_cmp_lt_u32 s3, 10
    s_cselect_b32 s50, s50, s11
    s_cselect_b32 s53, s53, s15
    s_cmovk_i32 s54, 6144
    s_cmovk_i32 s55, 256
    s_cmovk_i32 s51, 768
    s_cmovk_i32 s49, 0
    s_cmovk_i32 s48, 752
    s_mul_i32 s11, s55, s6
    s_lshl1_add_u32 s50, s11, s50
    v_lshrrev_b32 v44, 5, v0
    v_and_b32 v2, 16, v0
    v_lshl_add_u32 v2, v6, 5, v2
    v_mad_u32_u24 v2, v44, s54, v2
    v_mad_u32_u24 v2, v5, s55, v2
    v_cndmask_b32 v2, v31, v2, vcc
    v_min_u32 v47, s48, v46
    v_mad_u32_u24 v47, v44, s49, v47
    s_mov_b32 s14, s10
    v_lshlrev_b32 v36, 4, v0
    s_mov_b64 s[10:11], 0xffff
    v_cmp_gt_u32 vcc, 4, v6
    v_lshlrev_b64 v[36:37], v36, s[10:11]
    v_mov_b32 v38, 0
    v_cndmask_b32 v32, 0, v36, vcc
    v_cndmask_b32 v33, 0, v37, vcc
    v_cndmask_b32 v34, v36, v38, vcc
    v_cndmask_b32 v35, v37, v38, vcc
    s_mov_b32 s60, 0xffff0000
    s_mov_b32 s61, 0x3f803f80
    s_movk_i32 s62, 0xff00
    v_mov_b32 v20, 0
    v_mov_b32 v21, 0
    v_mov_b32 v45, 0xff
    v_lshlrev_b32 v28, 9, v5
    v_lshl_add_u32 v29, v7, 4, v28
    v_mul_u32_u24 v30, 80, v4
    v_add_u32 v30, v30, v28
    s_waitcnt vmcnt(20)
    v_dot2c_f32_bf16 v20, s61, v8
    v_dot2c_f32_bf16 v20, s61, v9
    v_dot2c_f32_bf16 v20, s61, v10
    v_dot2c_f32_bf16 v20, s61, v11
    v_dot2c_f32_bf16 v20, s61, v12
    v_dot2c_f32_bf16 v20, s61, v13
    v_dot2c_f32_bf16 v20, s61, v14
    v_dot2c_f32_bf16 v20, s61, v15
    v_dot2c_f32_bf16 v20, s61, v16
    v_dot2c_f32_bf16 v20, s61, v17
    v_lshlrev_b32 v128, 16, v8
    v_and_b32 v129, s60, v8
    v_lshlrev_b32 v130, 16, v9
    v_and_b32 v131, s60, v9
    v_lshlrev_b32 v132, 16, v10
    v_and_b32 v133, s60, v10
    v_lshlrev_b32 v134, 16, v11
    v_and_b32 v135, s60, v11
    v_lshlrev_b32 v136, 16, v12
    v_and_b32 v137, s60, v12
    v_lshlrev_b32 v138, 16, v13
    v_and_b32 v139, s60, v13
    v_lshlrev_b32 v140, 16, v14
    v_and_b32 v141, s60, v14
    v_lshlrev_b32 v142, 16, v15
    v_and_b32 v143, s60, v15
    v_lshlrev_b32 v144, 16, v16
    v_and_b32 v145, s60, v16
    v_lshlrev_b32 v146, 16, v17
    v_and_b32 v147, s60, v17
    v_add_f32_dpp v20, v20, v20 quad_perm:[1,0,3,2] row_mask:0xf bank_mask:0xf
    s_nop 1
    v_add_f32_dpp v20, v20, v20 quad_perm:[2,3,0,1] row_mask:0xf bank_mask:0xf
    s_nop 1
    v_add_f32_dpp v20, v20, v20 row_half_mirror row_mask:0xf bank_mask:0xf
    v_mov_b32 v22, v20
    s_nop 1
    v_permlane16_swap_b32 v20, v22
    v_add_f32 v20, v20, v22
    v_mov_b32 v22, v20
    s_nop 1
    v_permlane32_swap_b32 v20, v22
    v_add_f32 v20, v20, v22
    v_mul_f32 v20, 0x3acccccd, v20
    v_sub_f32 v128, v128, v20
    v_sub_f32 v129, v129, v20
    v_sub_f32 v130, v130, v20
    v_sub_f32 v131, v131, v20
    v_sub_f32 v132, v132, v20
    v_sub_f32 v133, v133, v20
    v_sub_f32 v134, v134, v20
    v_sub_f32 v135, v135, v20
    v_sub_f32 v136, v136, v20
    v_sub_f32 v137, v137, v20
    v_sub_f32 v138, v138, v20
    v_sub_f32 v139, v139, v20
    v_sub_f32 v140, v140, v20
    v_sub_f32 v141, v141, v20
    v_sub_f32 v142, v142, v20
    v_sub_f32 v143, v143, v20
    v_sub_f32 v144, v144, v20
    v_sub_f32 v145, v145, v20
    v_sub_f32 v146, v146, v20
    v_sub_f32 v147, v147, v20
    v_fmac_f32 v21, v128, v128
    v_fmac_f32 v21, v129, v129
    v_fmac_f32 v21, v130, v130
    v_fmac_f32 v21, v131, v131
    v_fmac_f32 v21, v132, v132
    v_fmac_f32 v21, v133, v133
    v_fmac_f32 v21, v134, v134
    v_fmac_f32 v21, v135, v135
    v_fmac_f32 v21, v136, v136
    v_fmac_f32 v21, v137, v137
    v_fmac_f32 v21, v138, v138
    v_fmac_f32 v21, v139, v139
    v_fmac_f32 v21, v140, v140
    v_fmac_f32 v21, v141, v141
    v_fmac_f32 v21, v142, v142
    v_fmac_f32 v21, v143, v143
    v_fmac_f32 v21, v144, v144
    v_fmac_f32 v21, v145, v145
    v_fmac_f32 v21, v146, v146
    v_fmac_f32 v21, v147, v147
    v_cvt_pk_bf16_f32 v20, v20, v20
    v_and_b32 v20, s60, v20
    v_add_f32_dpp v21, v21, v21 quad_perm:[1,0,3,2] row_mask:0xf bank_mask:0xf
    s_nop 1
    v_add_f32_dpp v21, v21, v21 quad_perm:[2,3,0,1] row_mask:0xf bank_mask:0xf
    s_nop 1
    v_add_f32_dpp v21, v21, v21 row_half_mirror row_mask:0xf bank_mask:0xf
    v_mov_b32 v22, v21
    s_nop 1
    v_permlane16_swap_b32 v21, v22
    v_add_f32 v21, v21, v22
    v_mov_b32 v22, v21
    s_nop 1
    v_permlane32_swap_b32 v21, v22
    v_add_f32 v21, v21, v22
    v_mul_f32 v21, 0x3acccccd, v21
    v_lshlrev_b32 v24, 16, v18
    v_cvt_pk_bf16_f32 v21, v21, v21
    v_and_b32 v25, s60, v18
    v_and_b32 v21, s60, v21
    v_lshlrev_b32 v26, 16, v19
    v_add_f32 v21, 0x3727c5ac, v21
    v_and_b32 v27, s60, v19
    v_cvt_pk_bf16_f32 v21, v21, v21
    v_and_b32 v21, s60, v21
    v_sqrt_f32 v21, v21
    v_sub_f32 v24, v24, v20
    v_sub_f32 v25, v25, v20
    v_sub_f32 v26, v26, v20
    v_sub_f32 v27, v27, v20
    v_cvt_pk_bf16_f32 v21, v21, v21
    v_cvt_pk_bf16_f32 v25, v24, v25
    v_cvt_pk_bf16_f32 v27, v26, v27
    v_and_b32 v21, s60, v21
    v_rcp_f32 v21, v21
    v_lshlrev_b32 v24, 16, v25
    v_and_b32 v25, s60, v25
    v_lshlrev_b32 v26, 16, v27
    v_and_b32 v27, s60, v27
    v_mul_f32 v24, v24, v21
    v_mul_f32 v25, v25, v21
    v_mul_f32 v26, v26, v21
    v_mul_f32 v27, v27, v21
    v_cvt_pk_bf16_f32 v24, v24, v24
    v_cvt_pk_bf16_f32 v25, v25, v25
    v_cvt_pk_bf16_f32 v26, v26, v26
    v_cvt_pk_bf16_f32 v27, v27, v27
    ds_write_b128 v29, v[24:27] offset:2048
    s_waitcnt lgkmcnt(0)
    ds_read_b128 v[128:131], v30 offset:2048
    ds_read_b128 v[132:135], v30 offset:2064
    ds_read_b128 v[136:139], v30 offset:2080
    ds_read_b128 v[140:143], v30 offset:2096
    ds_read_b128 v[144:147], v30 offset:2112
    v_lshrrev_b32 v44, 1, v0
    v_xor_b32 v44, v44, v0
    v_and_b32 v44, 1, v44
    v_mul_u32_u24 v44, 3, v44
    v_xor_b32 v44, v44, v0
    v_lshlrev_b32 v44, 3, v44
    v_mov_b32 v10, 0
    v_mov_b32 v11, 108
    s_waitcnt lgkmcnt(0)
    v_and_b32 v36, v32, v128
    v_and_b32 v37, v33, v128
    v_and_b32 v38, v34, v128
    v_and_b32 v39, v35, v128
    v_and_b32 v40, v32, v129
    v_and_b32 v41, v33, v129
    v_and_b32 v42, v34, v129
    v_and_b32 v43, v35, v129
    s_waitcnt vmcnt(15)
    v_mfma_f32_16x16x32_bf16 v[20:23], v[36:39], v[48:51], 0
    v_and_b32 v36, v32, v130
    v_and_b32 v37, v33, v130
    v_and_b32 v38, v34, v130
    v_and_b32 v39, v35, v130
    v_mfma_f32_16x16x32_bf16 v[20:23], v[40:43], v[52:55], v[20:23]
    v_and_b32 v40, v32, v131
    v_and_b32 v41, v33, v131
    v_and_b32 v42, v34, v131
    v_and_b32 v43, v35, v131
    v_mfma_f32_16x16x32_bf16 v[20:23], v[36:39], v[56:59], v[20:23]
    v_and_b32 v36, v32, v132
    v_and_b32 v37, v33, v132
    v_and_b32 v38, v34, v132
    v_and_b32 v39, v35, v132
    v_mfma_f32_16x16x32_bf16 v[20:23], v[40:43], v[60:63], v[20:23]
    v_and_b32 v40, v32, v133
    v_and_b32 v41, v33, v133
    v_and_b32 v42, v34, v133
    v_and_b32 v43, v35, v133
    v_mfma_f32_16x16x32_bf16 v[20:23], v[36:39], v[64:67], v[20:23]
    v_and_b32 v36, v32, v134
    v_and_b32 v37, v33, v134
    v_and_b32 v38, v34, v134
    v_and_b32 v39, v35, v134
    s_waitcnt vmcnt(10)
    v_mfma_f32_16x16x32_bf16 v[20:23], v[40:43], v[68:71], v[20:23]
    v_and_b32 v40, v32, v135
    v_and_b32 v41, v33, v135
    v_and_b32 v42, v34, v135
    v_and_b32 v43, v35, v135
    v_mfma_f32_16x16x32_bf16 v[20:23], v[36:39], v[72:75], v[20:23]
    v_and_b32 v36, v32, v136
    v_and_b32 v37, v33, v136
    v_and_b32 v38, v34, v136
    v_and_b32 v39, v35, v136
    v_mfma_f32_16x16x32_bf16 v[20:23], v[40:43], v[76:79], v[20:23]
    v_and_b32 v40, v32, v137
    v_and_b32 v41, v33, v137
    v_and_b32 v42, v34, v137
    v_and_b32 v43, v35, v137
    v_mfma_f32_16x16x32_bf16 v[20:23], v[36:39], v[80:83], v[20:23]
    v_and_b32 v36, v32, v138
    v_and_b32 v37, v33, v138
    v_and_b32 v38, v34, v138
    v_and_b32 v39, v35, v138
    v_mfma_f32_16x16x32_bf16 v[20:23], v[40:43], v[84:87], v[20:23]
    v_and_b32 v40, v32, v139
    v_and_b32 v41, v33, v139
    v_and_b32 v42, v34, v139
    v_and_b32 v43, v35, v139
    s_waitcnt vmcnt(5)
    v_mfma_f32_16x16x32_bf16 v[20:23], v[36:39], v[88:91], v[20:23]
    v_and_b32 v36, v32, v140
    v_and_b32 v37, v33, v140
    v_and_b32 v38, v34, v140
    v_and_b32 v39, v35, v140
    v_mfma_f32_16x16x32_bf16 v[20:23], v[40:43], v[92:95], v[20:23]
    v_and_b32 v40, v32, v141
    v_and_b32 v41, v33, v141
    v_and_b32 v42, v34, v141
    v_and_b32 v43, v35, v141
    v_mfma_f32_16x16x32_bf16 v[20:23], v[36:39], v[96:99], v[20:23]
    v_and_b32 v36, v32, v142
    v_and_b32 v37, v33, v142
    v_and_b32 v38, v34, v142
    v_and_b32 v39, v35, v142
    v_mfma_f32_16x16x32_bf16 v[20:23], v[40:43], v[100:103], v[20:23]
    v_and_b32 v40, v32, v143
    v_and_b32 v41, v33, v143
    v_and_b32 v42, v34, v143
    v_and_b32 v43, v35, v143
    v_mfma_f32_16x16x32_bf16 v[20:23], v[36:39], v[104:107], v[20:23]
    v_and_b32 v36, v32, v144
    v_and_b32 v37, v33, v144
    v_and_b32 v38, v34, v144
    v_and_b32 v39, v35, v144
    s_waitcnt vmcnt(0)
    v_mfma_f32_16x16x32_bf16 v[20:23], v[40:43], v[108:111], v[20:23]
    v_and_b32 v40, v32, v145
    v_and_b32 v41, v33, v145
    v_and_b32 v42, v34, v145
    v_and_b32 v43, v35, v145
    v_mfma_f32_16x16x32_bf16 v[20:23], v[36:39], v[112:115], v[20:23]
    v_and_b32 v36, v32, v146
    v_and_b32 v37, v33, v146
    v_and_b32 v38, v34, v146
    v_and_b32 v39, v35, v146
    v_mfma_f32_16x16x32_bf16 v[20:23], v[40:43], v[116:119], v[20:23]
    v_and_b32 v40, v32, v147
    v_and_b32 v41, v33, v147
    v_and_b32 v42, v34, v147
    v_and_b32 v43, v35, v147
    v_mfma_f32_16x16x32_bf16 v[20:23], v[36:39], v[120:123], v[20:23]
    s_nop 0
    v_mfma_f32_16x16x32_bf16 v[20:23], v[40:43], v[124:127], v[20:23]
    s_add_u32 s56, s56, 0x9b5f3701
    s_lshr_b32 s57, s56, 8
    s_lshr_b32 s58, s56, 16
    s_lshr_b32 s59, s56, 24
L_go:
    ds_read_b32 v9, v10 offset:96
    s_waitcnt lgkmcnt(0)
    v_cmp_eq_u32 vcc, 0, v9
    s_cbranch_vccnz L_go
    v_readfirstlane_b32 s63, v9
    v_bfi_b32 v21, v45, s57, v21
    v_bfi_b32 v22, v45, s58, v22
    v_bfi_b32 v23, v45, s59, v23
    v_bfi_b32 v20, v45, s56, v20
    s_cmp_lg_u32 s63, 2
    s_cbranch_scc1 L_far0
    buffer_store_dwordx4 v[20:23], v2, s[40:43], s50 offen
L_back0:
    s_cmp_eq_u32 s3, 8
    s_cbranch_scc1 L_tr
    s_cmp_lt_u32 s8, 2
    s_cbranch_scc1 L_xc
    s_cmp_eq_u32 s3, 9
    s_cbranch_scc1 L_w1
    v_mov_b32 v11, 104
L_tr:
    ds_read_b32 v9, v11
    s_waitcnt lgkmcnt(0)
    v_cmp_eq_u32 vcc, 0, v9
    s_cbranch_vccnz L_tr
L_g0:
    s_mov_b32 s49, s53
    s_cmp_lg_u32 s63, 2
    s_cbranch_scc1 L_far1
    buffer_load_dwordx4 v[48:51], v47, s[40:43], s49 offen nt
    s_add_u32 s49, s49, s51
    buffer_load_dwordx4 v[52:55], v47, s[40:43], s49 offen nt
    s_add_u32 s49, s49, s51
    buffer_load_dwordx4 v[56:59], v47, s[40:43], s49 offen nt
    s_add_u32 s49, s49, s51
    buffer_load_dwordx4 v[60:63], v47, s[40:43], s49 offen nt
    s_add_u32 s49, s49, s51
    buffer_load_dwordx4 v[64:67], v47, s[40:43], s49 offen nt
    s_add_u32 s49, s49, s51
    buffer_load_dwordx4 v[68:71], v47, s[40:43], s49 offen nt
    s_add_u32 s49, s49, s51
    buffer_load_dwordx4 v[72:75], v47, s[40:43], s49 offen nt
    s_add_u32 s49, s49, s51
    buffer_load_dwordx4 v[76:79], v47, s[40:43], s49 offen nt
L_back1:
    s_sub_u32 s52, s52, 1
    s_waitcnt vmcnt(0)
    v_xor_b32 v8, s56, v48
    v_bitop3_b32 v8, v8, v49, s57 bitop3:0xf6
    v_bitop3_b32 v8, v8, v50, s58 bitop3:0xf6
    v_bitop3_b32 v8, v8, v51, s59 bitop3:0xf6
    v_bitop3_b32 v8, v8, v52, s56 bitop3:0xf6
    v_bitop3_b32 v8, v8, v53, s57 bitop3:0xf6
    v_bitop3_b32 v8, v8, v54, s58 bitop3:0xf6
    v_bitop3_b32 v8, v8, v55, s59 bitop3:0xf6
    v_bitop3_b32 v8, v8, v56, s56 bitop3:0xf6
    v_bitop3_b32 v8, v8, v57, s57 bitop3:0xf6
    v_bitop3_b32 v8, v8, v58, s58 bitop3:0xf6
    v_bitop3_b32 v8, v8, v59, s59 bitop3:0xf6
    v_bitop3_b32 v8, v8, v60, s56 bitop3:0xf6
    v_bitop3_b32 v8, v8, v61, s57 bitop3:0xf6
    v_bitop3_b32 v8, v8, v62, s58 bitop3:0xf6
    v_bitop3_b32 v8, v8, v63, s59 bitop3:0xf6
    v_bitop3_b32 v8, v8, v64, s56 bitop3:0xf6
    v_bitop3_b32 v8, v8, v65, s57 bitop3:0xf6
    v_bitop3_b32 v8, v8, v66, s58 bitop3:0xf6
    v_bitop3_b32 v8, v8, v67, s59 bitop3:0xf6
    v_bitop3_b32 v8, v8, v68, s56 bitop3:0xf6
    v_bitop3_b32 v8, v8, v69, s57 bitop3:0xf6
    v_bitop3_b32 v8, v8, v70, s58 bitop3:0xf6
    v_bitop3_b32 v8, v8, v71, s59 bitop3:0xf6
    v_bitop3_b32 v8, v8, v72, s56 bitop3:0xf6
    v_bitop3_b32 v8, v8, v73, s57 bitop3:0xf6
    v_bitop3_b32 v8, v8, v74, s58 bitop3:0xf6
    v_bitop3_b32 v8, v8, v75, s59 bitop3:0xf6
    v_bitop3_b32 v8, v8, v76, s56 bitop3:0xf6
    v_bitop3_b32 v8, v8, v77, s57 bitop3:0xf6
    v_bitop3_b32 v8, v8, v78, s58 bitop3:0xf6
    v_bitop3_b32 v8, v8, v79, s59 bitop3:0xf6
    v_cmp_ne_u32_sdwa vcc, v8, 0 src0_sel:BYTE_0 src1_sel:DWORD
    s_cbranch_scc1 L_g0done
    s_mov_b64 exec, vcc
    s_cbranch_execnz L_g0
L_g0done:
    s_mov_b64 exec, -1
    v_and_b32 v48, s62, v48
    v_and_b32 v49, s62, v49
    v_and_b32 v50, s62, v50
    v_and_b32 v51, s62, v51
    v_and_b32 v52, s62, v52
    v_and_b32 v53, s62, v53
    v_and_b32 v54, s62, v54
    v_and_b32 v55, s62, v55
    v_and_b32 v56, s62, v56
    v_and_b32 v57, s62, v57
    v_and_b32 v58, s62, v58
    v_and_b32 v59, s62, v59
    v_and_b32 v60, s62, v60
    v_and_b32 v61, s62, v61
    v_and_b32 v62, s62, v62
    v_and_b32 v63, s62, v63
    v_and_b32 v64, s62, v64
    v_and_b32 v65, s62, v65
    v_and_b32 v66, s62, v66
    v_and_b32 v67, s62, v67
    v_and_b32 v68, s62, v68
    v_and_b32 v69, s62, v69
    v_and_b32 v70, s62, v70
    v_and_b32 v71, s62, v71
    v_and_b32 v72, s62, v72
    v_and_b32 v73, s62, v73
    v_and_b32 v74, s62, v74
    v_and_b32 v75, s62, v75
    v_and_b32 v76, s62, v76
    v_and_b32 v77, s62, v77
    v_and_b32 v78, s62, v78
    v_and_b32 v79, s62, v79
    v_pk_add_f32 v[48:49], v[48:49], v[64:65]
    v_pk_add_f32 v[50:51], v[50:51], v[66:67]
    v_pk_add_f32 v[52:53], v[52:53], v[68:69]
    v_pk_add_f32 v[54:55], v[54:55], v[70:71]
    v_pk_add_f32 v[56:57], v[56:57], v[72:73]
    v_pk_add_f32 v[58:59], v[58:59], v[74:75]
    v_pk_add_f32 v[60:61], v[60:61], v[76:77]
    v_pk_add_f32 v[62:63], v[62:63], v[78:79]
    v_pk_add_f32 v[48:49], v[48:49], v[56:57]
    v_pk_add_f32 v[50:51], v[50:51], v[58:59]
    v_pk_add_f32 v[52:53], v[52:53], v[60:61]
    v_pk_add_f32 v[54:55], v[54:55], v[62:63]
    v_pk_add_f32 v[48:49], v[48:49], v[52:53]
    v_pk_add_f32 v[50:51], v[50:51], v[54:55]
    v_cvt_pk_bf16_f32 v8, v48, v49
    v_cvt_pk_bf16_f32 v9, v50, v51
    s_mov_b32 s52, 32768
    s_cmp_eq_u32 s3, 10
    s_cbranch_scc1 L_w2
    v_lshrrev_b32 v11, 1, v47
    ds_write_b64 v11, v[8:9] offset:128
    ds_write_b32 v10, v45 offset:104
    s_lshl_b32 s54, s4, 9
    s_add_u32 s54, s54, 786432
    s_lshl_b32 s55, s5, 7
    s_add_u32 s55, s55, s54
    s_and_b32 s11, s13, 1
    s_lshl1_add_u32 s11, s7, s11
    s_lshl2_add_u32 s11, s11, s5
    s_and_b32 s15, s8, 3
    s_lshl2_add_u32 s11, s11, s15
    s_mulk_i32 s11, 768
    s_add_u32 s50, s11, 589824
    v_lshlrev_b32 v12, 3, v6
    v_and_b32 v13, 0x1f0, v46
    v_mov_b32 v17, s56
    v_mov_b32 v19, s56
L_ml:
    ds_read_b64 v[8:9], v12 offset:0
    s_waitcnt lgkmcnt(0)
    v_cmp_eq_u32 vcc, 0, v9
    s_cbranch_vccnz L_ml
    v_mov_b32 v16, v8
    v_mov_b32 v18, v9
    s_mov_b64 exec, 0xff
    s_cmp_lg_u32 s63, 2
    s_cbranch_scc1 L_far2
    buffer_store_dwordx4 v[16:19], v46, s[40:43], s55 offen
L_back2:
    s_mov_b64 exec, -1
L_mx:
    s_cmp_lg_u32 s63, 2
    s_cbranch_scc1 L_far3
    buffer_load_dwordx4 v[20:23], v13, s[40:43], s54 offen nt
L_back3:
    s_sub_u32 s52, s52, 1
    s_waitcnt vmcnt(0)
    v_xor_b32 v24, s56, v21
    v_bitop3_b32 v24, v24, v23, s56 bitop3:0xf6
    v_cmp_ne_u32 vcc, 0, v24
    s_cbranch_scc1 L_mxdone
    s_mov_b64 exec, vcc
    s_cbranch_execnz L_mx
L_mxdone:
    s_mov_b64 exec, -1
    s_nop 1
    v_max_f32_dpp v24, v20, v20 quad_perm:[1,0,3,2] row_mask:0xf bank_mask:0xf
    s_nop 1
    v_max_f32_dpp v24, v24, v24 quad_perm:[2,3,0,1] row_mask:0xf bank_mask:0xf
    s_nop 1
    v_max_f32_dpp v24, v24, v24 row_half_mirror row_mask:0xf bank_mask:0xf
    s_nop 1
    v_max_f32_dpp v24, v24, v24 row_mirror row_mask:0xf bank_mask:0xf
    v_mov_b32 v25, v24
    s_nop 1
    v_permlane16_swap_b32 v24, v25
    v_max_f32 v24, v24, v25
    v_sub_f32 v20, v20, v24
    v_sub_f32 v8, v8, v24
    v_exp_f32 v20, v20
    v_exp_f32 v8, v8
    v_mul_f32 v20, v20, v22
    s_nop 1
    v_add_f32_dpp v20, v20, v20 quad_perm:[1,0,3,2] row_mask:0xf bank_mask:0xf
    s_nop 1
    v_add_f32_dpp v20, v20, v20 quad_perm:[2,3,0,1] row_mask:0xf bank_mask:0xf
    s_nop 1
    v_add_f32_dpp v20, v20, v20 row_half_mirror row_mask:0xf bank_mask:0xf
    s_nop 1
    v_add_f32_dpp v20, v20, v20 row_mirror row_mask:0xf bank_mask:0xf
    v_mov_b32 v25, v20
    s_nop 1
    v_permlane16_swap_b32 v20, v25
    v_add_f32 v20, v20, v25
    v_rcp_f32 v20, v20
    s_nop 0
    v_mul_f32 v8, v8, v20
    s_nop 1
    v_mov_b32_dpp v24, v8 row_newbcast:0 row_mask:0xf bank_mask:0xf
    v_mov_b32_dpp v25, v8 row_newbcast:1 row_mask:0xf bank_mask:0xf
    v_mov_b32_dpp v26, v8 row_newbcast:2 row_mask:0xf bank_mask:0xf
    v_mov_b32_dpp v27, v8 row_newbcast:3 row_mask:0xf bank_mask:0xf
    v_mov_b32_dpp v28, v8 row_newbcast:4 row_mask:0xf bank_mask:0xf
    v_mov_b32_dpp v29, v8 row_newbcast:5 row_mask:0xf bank_mask:0xf
    v_mov_b32_dpp v30, v8 row_newbcast:6 row_mask:0xf bank_mask:0xf
    v_mov_b32_dpp v31, v8 row_newbcast:7 row_mask:0xf bank_mask:0xf
    s_mov_b32 exec_lo, 0xffffffff
    s_mov_b32 exec_hi, 0xffff
    s_barrier
    ds_read_b128 v[48:51], v46 offset:3072
    ds_read_b128 v[52:55], v46 offset:3840
    ds_read_b128 v[56:59], v46 offset:4608
    ds_read_b128 v[60:63], v46 offset:5376
    ds_read_b128 v[64:67], v46 offset:6144
    ds_read_b128 v[68:71], v46 offset:6912
    ds_read_b128 v[72:75], v46 offset:7680
    ds_read_b128 v[76:79], v46 offset:8448
    ds_read_b128 v[80:83], v46 offset:9216
    ds_read_b128 v[84:87], v46 offset:9984
    ds_read_b128 v[88:91], v46 offset:10752
    ds_read_b128 v[92:95], v46 offset:11520
    s_waitcnt lgkmcnt(10)
    ds_read_b128 v[96:99], v46 offset:12288
    ds_read_b128 v[100:103], v46 offset:13056
    v_pk_mul_f32 v[20:21], v[48:49], v[24:25] op_sel_hi:[1,0]
    v_pk_mul_f32 v[22:23], v[50:51], v[24:25] op_sel_hi:[1,0]
    v_pk_fma_f32 v[20:21], v[52:53], v[24:25], v[20:21] op_sel:[0,0,0] op_sel_hi:[1,0,1]
    v_pk_fma_f32 v[22:23], v[54:55], v[24:25], v[22:23] op_sel:[0,0,0] op_sel_hi:[1,0,1]
    s_waitcnt lgkmcnt(10)
    ds_read_b128 v[104:107], v46 offset:13824
    ds_read_b128 v[108:111], v46 offset:14592
    v_pk_fma_f32 v[20:21], v[56:57], v[24:25], v[20:21] op_sel:[0,1,0] op_sel_hi:[1,1,1]
    v_pk_fma_f32 v[22:23], v[58:59], v[24:25], v[22:23] op_sel:[0,1,0] op_sel_hi:[1,1,1]
    v_pk_fma_f32 v[20:21], v[60:61], v[24:25], v[20:21] op_sel:[0,1,0] op_sel_hi:[1,1,1]
    v_pk_fma_f32 v[22:23], v[62:63], v[24:25], v[22:23] op_sel:[0,1,0] op_sel_hi:[1,1,1]
    s_waitcnt lgkmcnt(10)
    v_pk_fma_f32 v[20:21], v[64:65], v[26:27], v[20:21] op_sel:[0,0,0] op_sel_hi:[1,0,1]
    v_pk_fma_f32 v[22:23], v[66:67], v[26:27], v[22:23] op_sel:[0,0,0] op_sel_hi:[1,0,1]
    v_pk_fma_f32 v[20:21], v[68:69], v[26:27], v[20:21] op_sel:[0,0,0] op_sel_hi:[1,0,1]
    v_pk_fma_f32 v[22:23], v[70:71], v[26:27], v[22:23] op_sel:[0,0,0] op_sel_hi:[1,0,1]
    s_waitcnt lgkmcnt(8)
    v_pk_fma_f32 v[20:21], v[72:73], v[26:27], v[20:21] op_sel:[0,1,0] op_sel_hi:[1,1,1]
    v_pk_fma_f32 v[22:23], v[74:75], v[26:27], v[22:23] op_sel:[0,1,0] op_sel_hi:[1,1,1]
    v_pk_fma_f32 v[20:21], v[76:77], v[26:27], v[20:21] op_sel:[0,1,0] op_sel_hi:[1,1,1]
    v_pk_fma_f32 v[22:23], v[78:79], v[26:27], v[22:23] op_sel:[0,1,0] op_sel_hi:[1,1,1]
    s_waitcnt lgkmcnt(6)
    v_pk_fma_f32 v[20:21], v[80:81], v[28:29], v[20:21] op_sel:[0,0,0] op_sel_hi:[1,0,1]
    v_pk_fma_f32 v[22:23], v[82:83], v[28:29], v[22:23] op_sel:[0,0,0] op_sel_hi:[1,0,1]
    v_pk_fma_f32 v[20:21], v[84:85], v[28:29], v[20:21] op_sel:[0,0,0] op_sel_hi:[1,0,1]
    v_pk_fma_f32 v[22:23], v[86:87], v[28:29], v[22:23] op_sel:[0,0,0] op_sel_hi:[1,0,1]
    s_waitcnt lgkmcnt(4)
    v_pk_fma_f32 v[20:21], v[88:89], v[28:29], v[20:21] op_sel:[0,1,0] op_sel_hi:[1,1,1]
    v_pk_fma_f32 v[22:23], v[90:91], v[28:29], v[22:23] op_sel:[0,1,0] op_sel_hi:[1,1,1]
    v_pk_fma_f32 v[20:21], v[92:93], v[28:29], v[20:21] op_sel:[0,1,0] op_sel_hi:[1,1,1]
    v_pk_fma_f32 v[22:23], v[94:95], v[28:29], v[22:23] op_sel:[0,1,0] op_sel_hi:[1,1,1]
    s_waitcnt lgkmcnt(2)
    v_pk_fma_f32 v[20:21], v[96:97], v[30:31], v[20:21] op_sel:[0,0,0] op_sel_hi:[1,0,1]
    v_pk_fma_f32 v[22:23], v[98:99], v[30:31], v[22:23] op_sel:[0,0,0] op_sel_hi:[1,0,1]
    v_pk_fma_f32 v[20:21], v[100:101], v[30:31], v[20:21] op_sel:[0,0,0] op_sel_hi:[1,0,1]
    v_pk_fma_f32 v[22:23], v[102:103], v[30:31], v[22:23] op_sel:[0,0,0] op_sel_hi:[1,0,1]
    s_waitcnt lgkmcnt(0)
    v_pk_fma_f32 v[20:21], v[104:105], v[30:31], v[20:21] op_sel:[0,1,0] op_sel_hi:[1,1,1]
    v_pk_fma_f32 v[22:23], v[106:107], v[30:31], v[22:23] op_sel:[0,1,0] op_sel_hi:[1,1,1]
    v_pk_fma_f32 v[20:21], v[108:109], v[30:31], v[20:21] op_sel:[0,1,0] op_sel_hi:[1,1,1]
    v_pk_fma_f32 v[22:23], v[110:111], v[30:31], v[22:23] op_sel:[0,1,0] op_sel_hi:[1,1,1]
    v_bfi_b32 v20, v45, s56, v20
    v_bfi_b32 v21, v45, s57, v21
    v_bfi_b32 v22, v45, s58, v22
    v_bfi_b32 v23, v45, s59, v23
    s_cmp_lg_u32 s63, 2
    s_cbranch_scc1 L_far4
    buffer_store_dwordx4 v[20:23], v46, s[40:43], s50 offen
L_back4:
    s_barrier
L_hend:
    s_endpgm
L_w2:
    v_mov_b32 v10, v8
    v_mov_b32 v11, v9
    s_mov_b32 s6, 0xc0135761
    s_mov_b32 s11, 0xbdd2d3e8
    v_permlane32_swap_b32 v8, v10
    v_permlane32_swap_b32 v9, v11
    v_mov_b32 v24, s6
    v_lshlrev_b32 v12, 16, v8
    v_and_b32 v13, s60, v8
    v_lshlrev_b32 v14, 16, v9
    v_and_b32 v15, s60, v9
    v_mul_f32 v16, v12, v12
    v_mul_f32 v17, v13, v13
    v_mul_f32 v18, v14, v14
    v_mul_f32 v19, v15, v15
    v_fma_f32 v16, v16, s11, v24
    v_fma_f32 v17, v17, s11, v24
    v_fma_f32 v18, v18, s11, v24
    v_fma_f32 v19, v19, s11, v24
    v_mul_f32 v16, v16, v12
    v_mul_f32 v17, v17, v13
    v_mul_f32 v18, v18, v14
    v_mul_f32 v19, v19, v15
    v_exp_f32 v16, v16
    v_exp_f32 v17, v17
    v_exp_f32 v18, v18
    v_exp_f32 v19, v19
    v_add_f32 v16, 1.0, v16
    v_add_f32 v17, 1.0, v17
    v_add_f32 v18, 1.0, v18
    v_add_f32 v19, 1.0, v19
    v_rcp_f32 v16, v16
    v_rcp_f32 v17, v17
    v_rcp_f32 v18, v18
    v_rcp_f32 v19, v19
    v_mul_f32 v12, v16, v12
    v_mul_f32 v13, v17, v13
    v_mul_f32 v14, v18, v14
    v_mul_f32 v15, v19, v15
    v_cvt_pk_bf16_f32 v8, v12, v13
    v_cvt_pk_bf16_f32 v9, v14, v15
    v_lshlrev_b32 v16, 16, v10
    v_and_b32 v17, s60, v10
    v_lshlrev_b32 v18, 16, v11
    v_and_b32 v19, s60, v11
    v_lshlrev_b32 v12, 16, v8
    v_and_b32 v13, s60, v8
    v_lshlrev_b32 v14, 16, v9
    v_and_b32 v15, s60, v9
    v_mul_f32 v12, v16, v12
    v_mul_f32 v13, v17, v13
    v_mul_f32 v14, v18, v14
    v_mul_f32 v15, v19, v15
    v_cvt_pk_bf16_f32 v12, v12, v13
    v_cvt_pk_bf16_f32 v13, v14, v15
    v_lshl_add_u32 v10, v4, 9, v44
    s_mov_b32 exec_hi, 0
    ds_write_b64 v10, v[12:13] offset:1024
    s_mov_b32 exec_hi, -1
L_w1:
    s_sub_u32 s6, s3, 9
    s_lshl1_add_u32 s11, s7, s6
    s_mul_i32 s11, s11, 12
    s_add_u32 s11, s11, s9
    s_lshl_b32 s11, s11, 10
    s_add_u32 s53, s11, 589824
    s_add_u32 s54, s53, 6144
    s_mulk_i32 s6, 640
    v_add_u32 v44, s6, v44
    s_mov_b64 s[44:45], -1
    s_mov_b64 s[46:47], -1
    s_mov_b64 s[48:49], -1
    s_mov_b64 s[50:51], -1
    v_not_b32 v48, s56
    v_not_b32 v52, s56
    v_not_b32 v56, s56
    v_not_b32 v60, s56
    s_waitcnt lgkmcnt(0)
    v_mov_b32 v12, 0
    s_barrier
    s_barrier
L_gt0:
    ds_read_b32 v13, v12 offset:120
    s_waitcnt lgkmcnt(0)
    v_cmp_gt_u32 vcc, 8, v13
    s_cbranch_vccnz L_gt0
    s_cmp_lg_u32 s63, 2
    s_cbranch_scc1 L_far5
    buffer_load_dwordx4 v[48:51], v46, s[40:43], s53 offen offset:0 nt
    buffer_load_dwordx4 v[52:55], v46, s[40:43], s53 offen offset:3072 nt
    buffer_load_dwordx4 v[56:59], v46, s[40:43], s54 offen offset:0 nt
    buffer_load_dwordx4 v[60:63], v46, s[40:43], s54 offen offset:3072 nt
L_back5:
L_gt1:
    ds_read_b32 v13, v12 offset:120
    s_waitcnt lgkmcnt(0)
    v_cmp_gt_u32 vcc, 10, v13
    s_cbranch_vccnz L_gt1
    s_cmp_lg_u32 s63, 2
    s_cbranch_scc1 L_far6
    buffer_load_dwordx4 v[48:51], v46, s[40:43], s53 offen offset:0 nt
    buffer_load_dwordx4 v[52:55], v46, s[40:43], s53 offen offset:3072 nt
    buffer_load_dwordx4 v[56:59], v46, s[40:43], s54 offen offset:0 nt
    buffer_load_dwordx4 v[60:63], v46, s[40:43], s54 offen offset:3072 nt
L_back6:
L_gt2:
    ds_read_b32 v13, v12 offset:120
    s_waitcnt lgkmcnt(0)
    v_cmp_gt_u32 vcc, 14, v13
    s_cbranch_vccnz L_gt2
L_ga:
    s_cmp_lg_u32 s63, 2
    s_cbranch_scc1 L_far7
    s_mov_b64 exec, s[44:45]
    buffer_load_dwordx4 v[48:51], v46, s[40:43], s53 offen offset:0 nt
    s_mov_b64 exec, s[46:47]
    buffer_load_dwordx4 v[52:55], v46, s[40:43], s53 offen offset:3072 nt
    s_mov_b64 exec, s[48:49]
    buffer_load_dwordx4 v[56:59], v46, s[40:43], s54 offen offset:0 nt
    s_mov_b64 exec, s[50:51]
    buffer_load_dwordx4 v[60:63], v46, s[40:43], s54 offen offset:3072 nt
L_back7:
    s_mov_b64 exec, -1
    s_sub_u32 s52, s52, 1
    s_cbranch_scc1 L_gadone
    s_waitcnt vmcnt(11)
    v_xor_b32 v8, s56, v48
    v_bitop3_b32 v8, v8, v49, s57 bitop3:0xf6
    v_bitop3_b32 v8, v8, v50, s58 bitop3:0xf6
    v_bitop3_b32 v8, v8, v51, s59 bitop3:0xf6
    v_cmp_ne_u32_sdwa s[44:45], v8, 0 src0_sel:BYTE_0 src1_sel:DWORD
    s_waitcnt vmcnt(10)
    v_xor_b32 v9, s56, v52
    v_bitop3_b32 v9, v9, v53, s57 bitop3:0xf6
    v_bitop3_b32 v9, v9, v54, s58 bitop3:0xf6
    v_bitop3_b32 v9, v9, v55, s59 bitop3:0xf6
    v_cmp_ne_u32_sdwa s[46:47], v9, 0 src0_sel:BYTE_0 src1_sel:DWORD
    s_waitcnt vmcnt(9)
    v_xor_b32 v10, s56, v56
    v_bitop3_b32 v10, v10, v57, s57 bitop3:0xf6
    v_bitop3_b32 v10, v10, v58, s58 bitop3:0xf6
    v_bitop3_b32 v10, v10, v59, s59 bitop3:0xf6
    v_cmp_ne_u32_sdwa s[48:49], v10, 0 src0_sel:BYTE_0 src1_sel:DWORD
    s_waitcnt vmcnt(8)
    v_xor_b32 v11, s56, v60
    v_bitop3_b32 v11, v11, v61, s57 bitop3:0xf6
    v_bitop3_b32 v11, v11, v62, s58 bitop3:0xf6
    v_bitop3_b32 v11, v11, v63, s59 bitop3:0xf6
    v_cmp_ne_u32_sdwa s[50:51], v11, 0 src0_sel:BYTE_0 src1_sel:DWORD
    s_or_b64 s[10:11], s[44:45], s[46:47]
    s_or_b64 vcc, s[48:49], s[50:51]
    s_or_b64 vcc, vcc, s[10:11]
    s_cbranch_scc1 L_ga
L_gadone:
    v_and_b32 v64, s62, v48
    v_and_b32 v65, s62, v49
    v_and_b32 v66, s62, v50
    v_and_b32 v67, s62, v51
    v_and_b32 v68, s62, v52
    v_and_b32 v69, s62, v53
    v_and_b32 v70, s62, v54
    v_and_b32 v71, s62, v55
    v_and_b32 v72, s62, v56
    v_and_b32 v73, s62, v57
    v_and_b32 v74, s62, v58
    v_and_b32 v75, s62, v59
    v_and_b32 v76, s62, v60
    v_and_b32 v77, s62, v61
    v_and_b32 v78, s62, v62
    v_and_b32 v79, s62, v63
    v_pk_add_f32 v[64:65], v[64:65], v[72:73]
    v_pk_add_f32 v[66:67], v[66:67], v[74:75]
    v_pk_add_f32 v[68:69], v[68:69], v[76:77]
    v_pk_add_f32 v[70:71], v[70:71], v[78:79]
    v_pk_add_f32 v[64:65], v[64:65], v[68:69]
    v_pk_add_f32 v[66:67], v[66:67], v[70:71]
    v_cvt_pk_bf16_f32 v8, v64, v65
    v_cvt_pk_bf16_f32 v9, v66, v67
    ds_write_b64 v44, v[8:9] offset:512
    s_waitcnt lgkmcnt(0)
    s_barrier
    s_endpgm
L_xc:
    s_lshl2_add_u32 s12, s8, s63
    s_lshl4_add_u32 s12, s12, s3
    s_cmpk_lg_u32 s12, 105
    s_cbranch_scc1 L_hend
    s_lshl_b32 s20, s7, 14
    s_add_u32 s20, s20, 1179648
    v_lshl_add_u32 v9, v0, 9, s20
    s_mov_b64 exec, 0x1f001f
    global_load_dword v9, v9, s[38:39] sc1
    s_lshl_b32 s12, s7, 8
    s_add_u32 s12, s12, 843908
    v_mov_b32 v8, s12
    s_mov_b64 s[22:23], -1
    s_add_u32 s30, s20, 2560
    s_waitcnt vmcnt(0)
L_pr:
    s_memtime s[24:25]
    s_waitcnt lgkmcnt(0)
    s_load_dword s21, s[38:39], s20 glc
    s_waitcnt lgkmcnt(0)
    s_memtime s[26:27]
    s_waitcnt lgkmcnt(0)
    s_load_dword s21, s[38:39], s20 offset:8192 glc
    s_waitcnt lgkmcnt(0)
    s_memtime s[28:29]
    s_sub_u32 s24, s26, s24
    s_min_u32 s22, s22, s24
    s_addk_i32 s20, 512
    s_waitcnt lgkmcnt(0)
    s_sub_u32 s28, s28, s26
    s_min_u32 s23, s23, s28
    s_cmp_lt_u32 s20, s30
    s_cbranch_scc1 L_pr
    s_cmp_lt_u32 s23, s22
    s_addc_u32 s21, s56, 0
    v_mov_b32 v9, s21
    s_mov_b64 exec, 1
    global_store_dword v8, v9, s[38:39]
    s_endpgm
L_far0:
    buffer_store_dwordx4 v[20:23], v2, s[40:43], s50 offen sc1
    s_branch L_back0
L_far1:
    buffer_load_dwordx4 v[48:51], v47, s[40:43], s49 offen sc1
    s_add_u32 s49, s49, s51
    buffer_load_dwordx4 v[52:55], v47, s[40:43], s49 offen sc1
    s_add_u32 s49, s49, s51
    buffer_load_dwordx4 v[56:59], v47, s[40:43], s49 offen sc1
    s_add_u32 s49, s49, s51
    buffer_load_dwordx4 v[60:63], v47, s[40:43], s49 offen sc1
    s_add_u32 s49, s49, s51
    buffer_load_dwordx4 v[64:67], v47, s[40:43], s49 offen sc1
    s_add_u32 s49, s49, s51
    buffer_load_dwordx4 v[68:71], v47, s[40:43], s49 offen sc1
    s_add_u32 s49, s49, s51
    buffer_load_dwordx4 v[72:75], v47, s[40:43], s49 offen sc1
    s_add_u32 s49, s49, s51
    buffer_load_dwordx4 v[76:79], v47, s[40:43], s49 offen sc1
    s_branch L_back1
L_far2:
    buffer_store_dwordx4 v[16:19], v46, s[40:43], s55 offen sc1
    s_branch L_back2
L_far3:
    buffer_load_dwordx4 v[20:23], v13, s[40:43], s54 offen sc1
    s_branch L_back3
L_far4:
    buffer_store_dwordx4 v[20:23], v46, s[40:43], s50 offen sc1
    s_branch L_back4
L_far5:
    buffer_load_dwordx4 v[48:51], v46, s[40:43], s53 offen offset:0 sc1
    buffer_load_dwordx4 v[52:55], v46, s[40:43], s53 offen offset:3072 sc1
    buffer_load_dwordx4 v[56:59], v46, s[40:43], s54 offen offset:0 sc1
    buffer_load_dwordx4 v[60:63], v46, s[40:43], s54 offen offset:3072 sc1
    s_branch L_back5
L_far6:
    buffer_load_dwordx4 v[48:51], v46, s[40:43], s53 offen offset:0 sc1
    buffer_load_dwordx4 v[52:55], v46, s[40:43], s53 offen offset:3072 sc1
    buffer_load_dwordx4 v[56:59], v46, s[40:43], s54 offen offset:0 sc1
    buffer_load_dwordx4 v[60:63], v46, s[40:43], s54 offen offset:3072 sc1
    s_branch L_back6
L_far7:
    s_mov_b64 exec, s[44:45]
    buffer_load_dwordx4 v[48:51], v46, s[40:43], s53 offen offset:0 sc1
    s_mov_b64 exec, s[46:47]
    buffer_load_dwordx4 v[52:55], v46, s[40:43], s53 offen offset:3072 sc1
    s_mov_b64 exec, s[48:49]
    buffer_load_dwordx4 v[56:59], v46, s[40:43], s54 offen offset:0 sc1
    s_mov_b64 exec, s[50:51]
    buffer_load_dwordx4 v[60:63], v46, s[40:43], s54 offen offset:3072 sc1
    s_branch L_back7
.section .rodata,"a"
.p2align 6
.amdhsa_kernel parallel_sum__sliding_block_cached__glu_gated_geglu__decode_kernel
  .amdhsa_next_free_vgpr 168
  .amdhsa_next_free_sgpr 102
  .amdhsa_accum_offset 168
  .amdhsa_group_segment_fixed_size 0
  .amdhsa_kernarg_size 96
  .amdhsa_user_sgpr_count 2
  .amdhsa_user_sgpr_kernarg_segment_ptr 1
  .amdhsa_system_sgpr_workgroup_id_x 1
.end_amdhsa_kernel
```
